```python
import torch

def _softmax(x, axis=-1):
    return torch.softmax(x, dim=axis)
def _gelu(x):
    return torch.nn.functional.gelu(x, approximate="tanh")
def _silu(x):
    return torch.nn.functional.silu(x)
def _sigmoid(x):
    return torch.sigmoid(x)
def _layernorm(x, axis=-1, eps=1e-5):
    m = x.mean(dim=axis, keepdim=True)
    v = x.var(dim=axis, keepdim=True, unbiased=False)
    return (x - m) / torch.sqrt(v + eps)
def _scatter_add(tgt, idx, src, axis=0):
    return tgt.clone().index_add_(axis, idx, src)
def _segment_sum(src, seg, n):
    out = torch.zeros((n,) + src.shape[1:], dtype=src.dtype)
    return out.index_add_(0, seg, src)
def _pad(x, pw):
    flat = tuple(v for pair in reversed(pw) for v in pair)
    return torch.nn.functional.pad(x, flat)

kernel_name = 'concat_heads__ssm_conv_s5__mha_block__prompt'

def setup_inputs():

    _w = (lambda a: (lambda t: t.to(torch.bfloat16) if t.is_floating_point() else t)(torch.as_tensor(a)))
    def _A_setup():
        B, S, D = 1, 2048, 448
        P = D
        Lambda_re = -0.5 * (lambda _x: torch.exp(torch.as_tensor(_x)))((lambda *s: torch.randn(*s, dtype=torch.bfloat16) * 0.4)(P))
        Lambda_im = (lambda *s: torch.randn(*s, dtype=torch.bfloat16) * 0.8)(P) * 1.0
        B_re = (lambda *s: torch.randn(*s, dtype=torch.bfloat16) * 0.4)(P, D) * (D ** -0.5)
        B_im = (lambda *s: torch.randn(*s, dtype=torch.bfloat16) * 0.4)(P, D) * (D ** -0.5)
        C_re = (lambda *s: torch.randn(*s, dtype=torch.bfloat16) * 0.4)(D, P) * (P ** -0.5)
        C_im = (lambda *s: torch.randn(*s, dtype=torch.bfloat16) * 0.4)(D, P) * (P ** -0.5)
        log_dt = (lambda *s: torch.randn(*s, dtype=torch.bfloat16) * 0.4)(P) * 0.3 - 2.0
        Dskip = (lambda *s: torch.randn(*s, dtype=torch.bfloat16) * 0.05)(D)
        return {
            "x": _w((lambda *s: torch.randn(*s, dtype=torch.bfloat16) * 0.05)(B, S, D)),
            "Lambda_re": _w(Lambda_re),
            "Lambda_im": _w(Lambda_im),
            "B_re": _w(B_re),
            "B_im": _w(B_im),
            "C_re": _w(C_re),
            "C_im": _w(C_im),
            "log_dt": _w(log_dt),
            "Dskip": _w(Dskip),
        }
    _A_in = _A_setup()

    def _B_setup():
        B, S, D, H = 1, 2048, 448, 16
        return {
            "x": _w((lambda *s: torch.randn(*s, dtype=torch.bfloat16) * 0.2)(B, S, D)),
            "wqkv": _w((lambda *s: torch.randn(*s, dtype=torch.bfloat16) * 0.2)(D, 3 * D)),
            "wo": _w((lambda *s: torch.randn(*s, dtype=torch.bfloat16) * 0.05)(D, D)),
        }
    _B_in = _B_setup()

    return {
        "A_x": _A_in["x"],
        "A_Lambda_re": _A_in["Lambda_re"],
        "A_Lambda_im": _A_in["Lambda_im"],
        "A_B_re": _A_in["B_re"],
        "A_B_im": _A_in["B_im"],
        "A_C_re": _A_in["C_re"],
        "A_C_im": _A_in["C_im"],
        "A_log_dt": _A_in["log_dt"],
        "A_Dskip": _A_in["Dskip"],
        "B_x": _B_in["x"],
        "B_wqkv": _B_in["wqkv"],
        "B_wo": _B_in["wo"],
    }

def reference(A_x, A_Lambda_re, A_Lambda_im, A_B_re, A_B_im, A_C_re, A_C_im, A_log_dt, A_Dskip, B_x, B_wqkv, B_wo):
    def _A_ref(x, Lambda_re, Lambda_im, B_re, B_im, C_re, C_im, log_dt, Dskip):
        Bsz, L, H = x.shape
        Lam = Lambda_re + 1j * Lambda_im
        Bmat = B_re + 1j * B_im
        Cmat = C_re + 1j * C_im
        dt = torch.exp(log_dt)
        Lam_bar = torch.exp(dt * Lam)
        B_bar = ((Lam_bar - 1.0) / Lam)[:, None] * Bmat
        Bu = torch.einsum("bld,pd->blp", x + 0j, B_bar)
        h = torch.zeros_like(Bu[:, 0, :])
        hs = []
        for t in range(L):
            h = Lam_bar[None, :] * h + Bu[:, t, :]
            hs.append(h)
        hseq = torch.stack(hs, 1)
        y = 2.0 * torch.einsum("blp,dp->bld", hseq, Cmat).real + x * Dskip[None, None, :]
        return y

    def _B_ref(x, wqkv, wo):
        B, S, D = x.shape
        H = 16
        Dh = D // H
        qkv = (lambda x, *d: x.permute(*d))((x @ wqkv).reshape(B, S, 3, H, Dh), 2, 0, 3, 1, 4)
        q, k, v = qkv[0], qkv[1], qkv[2]
        scores = torch.einsum("bhqd,bhkd->bhqk", q, k) * (Dh ** -0.5)
        p = _softmax(scores, axis=-1)
        o = torch.einsum("bhqk,bhkd->bhqd", p, v)
        return (lambda x, *d: x.permute(*d))(o, 0, 2, 1, 3).reshape(B, S, D) @ wo

    a = _A_ref(A_x, A_Lambda_re, A_Lambda_im, A_B_re, A_B_im, A_C_re, A_C_im, A_log_dt, A_Dskip)
    b = _B_ref(B_x, B_wqkv, B_wo)
    return torch.concatenate([a, b], axis=-1)
```

```asm
; @launch kernel=k1_proj_kernel grid=(256,1,1) block=(256,1,1) lds=122880
; @launch kernel=k2_attn_kernel grid=(368,1,1) block=(512,1,1) lds=65536
; @launch kernel=k3_out_kernel grid=(224,1,1) block=(256,1,1) lds=114688
.amdgcn_target "amdgcn-amd-amdhsa--gfx950"
.text
.globl k1_proj_kernel
.p2align 8
.type k1_proj_kernel,@function
k1_proj_kernel:
    s_cmp_ge_u32 s2, 256
    s_cbranch_scc1 K1_END
    s_load_dwordx2 s[40:41], s[0:1], 112
    v_lshrrev_b32 v1, 6, v0
    v_and_b32 v2, 63, v0
    s_nop 0
    v_readfirstlane_b32 s3, v1
    s_lshr_b32 s18, s2, 3
    s_and_b32 s17, s2, 3
    s_lshl_b32 s20, s17, 2
    s_and_b32 s21, s18, 3
    s_add_u32 s20, s20, s21
    s_lshr_b32 s21, s18, 2
    s_lshl_b32 s16, s18, 2
    s_add_u32 s16, s16, s3
    s_bitcmp1_b32 s2, 2
    s_cbranch_scc1 K1_A
    s_load_dwordx2 s[36:37], s[0:1], 72
    s_load_dwordx2 s[38:39], s[0:1], 80
    s_and_b32 s22, s3, 1
    s_lshr_b32 s23, s3, 1
    s_lshl_b32 s24, s20, 7
    s_lshl_b32 s25, s3, 5
    s_add_u32 s24, s24, s25
    v_lshrrev_b32 v6, 3, v2
    v_add_u32 v6, s24, v6
    v_mul_u32_u24 v6, 896, v6
    v_and_b32 v7, 7, v2
    v_lshrrev_b32 v8, 4, v2
    v_xor_b32 v7, v7, v8
    v_lshl_add_u32 v4, v7, 4, v6
    v_xor_b32 v7, 4, v7
    v_lshl_add_u32 v5, v7, 4, v6
    s_mul_i32 s24, s3, 384
    s_mul_i32 s25, s21, 112
    s_mov_b32 s26, 0x7ffffff0
    v_add_u32 v6, s24, v2
    v_mul_u32_u24 v7, 2731, v6
    v_lshrrev_b32 v7, 16, v7
    v_mul_u32_u24 v8, 24, v7
    v_sub_u32 v8, v6, v8
    v_bfe_u32 v9, v7, 1, 1
    v_lshlrev_b32 v9, 2, v9
    v_xor_b32 v8, v8, v9
    v_mul_u32_u24 v9, 37, v8
    v_lshrrev_b32 v9, 8, v9
    v_mul_u32_u24 v16, 7, v9
    v_sub_u32 v16, v8, v16
    v_mul_u32_u24 v7, 2688, v7
    v_mul_u32_u24 v9, 896, v9
    v_add3_u32 v7, v7, v9, s25
    v_lshl_add_u32 v10, v16, 4, v7
    v_cmp_lt_u32 vcc, 20, v8
    v_mov_b32 v9, s26
    s_nop 0
    v_cndmask_b32 v10, v10, v9, vcc
    v_add_u32 v6, s24, v2
    v_add_u32 v6, 64, v6
    v_mul_u32_u24 v7, 2731, v6
    v_lshrrev_b32 v7, 16, v7
    v_mul_u32_u24 v8, 24, v7
    v_sub_u32 v8, v6, v8
    v_bfe_u32 v9, v7, 1, 1
    v_lshlrev_b32 v9, 2, v9
    v_xor_b32 v8, v8, v9
    v_mul_u32_u24 v9, 37, v8
    v_lshrrev_b32 v9, 8, v9
    v_mul_u32_u24 v16, 7, v9
    v_sub_u32 v16, v8, v16
    v_mul_u32_u24 v7, 2688, v7
    v_mul_u32_u24 v9, 896, v9
    v_add3_u32 v7, v7, v9, s25
    v_lshl_add_u32 v11, v16, 4, v7
    v_cmp_lt_u32 vcc, 20, v8
    v_mov_b32 v9, s26
    s_nop 0
    v_cndmask_b32 v11, v11, v9, vcc
    v_add_u32 v6, s24, v2
    v_add_u32 v6, 128, v6
    v_mul_u32_u24 v7, 2731, v6
    v_lshrrev_b32 v7, 16, v7
    v_mul_u32_u24 v8, 24, v7
    v_sub_u32 v8, v6, v8
    v_bfe_u32 v9, v7, 1, 1
    v_lshlrev_b32 v9, 2, v9
    v_xor_b32 v8, v8, v9
    v_mul_u32_u24 v9, 37, v8
    v_lshrrev_b32 v9, 8, v9
    v_mul_u32_u24 v16, 7, v9
    v_sub_u32 v16, v8, v16
    v_mul_u32_u24 v7, 2688, v7
    v_mul_u32_u24 v9, 896, v9
    v_add3_u32 v7, v7, v9, s25
    v_lshl_add_u32 v12, v16, 4, v7
    v_cmp_lt_u32 vcc, 20, v8
    v_mov_b32 v9, s26
    s_nop 0
    v_cndmask_b32 v12, v12, v9, vcc
    v_add_u32 v6, s24, v2
    v_add_u32 v6, 192, v6
    v_mul_u32_u24 v7, 2731, v6
    v_lshrrev_b32 v7, 16, v7
    v_mul_u32_u24 v8, 24, v7
    v_sub_u32 v8, v6, v8
    v_bfe_u32 v9, v7, 1, 1
    v_lshlrev_b32 v9, 2, v9
    v_xor_b32 v8, v8, v9
    v_mul_u32_u24 v9, 37, v8
    v_lshrrev_b32 v9, 8, v9
    v_mul_u32_u24 v16, 7, v9
    v_sub_u32 v16, v8, v16
    v_mul_u32_u24 v7, 2688, v7
    v_mul_u32_u24 v9, 896, v9
    v_add3_u32 v7, v7, v9, s25
    v_lshl_add_u32 v13, v16, 4, v7
    v_cmp_lt_u32 vcc, 20, v8
    v_mov_b32 v9, s26
    s_nop 0
    v_cndmask_b32 v13, v13, v9, vcc
    v_add_u32 v6, s24, v2
    v_add_u32 v6, 256, v6
    v_mul_u32_u24 v7, 2731, v6
    v_lshrrev_b32 v7, 16, v7
    v_mul_u32_u24 v8, 24, v7
    v_sub_u32 v8, v6, v8
    v_bfe_u32 v9, v7, 1, 1
    v_lshlrev_b32 v9, 2, v9
    v_xor_b32 v8, v8, v9
    v_mul_u32_u24 v9, 37, v8
    v_lshrrev_b32 v9, 8, v9
    v_mul_u32_u24 v16, 7, v9
    v_sub_u32 v16, v8, v16
    v_mul_u32_u24 v7, 2688, v7
    v_mul_u32_u24 v9, 896, v9
    v_add3_u32 v7, v7, v9, s25
    v_lshl_add_u32 v14, v16, 4, v7
    v_cmp_lt_u32 vcc, 20, v8
    v_mov_b32 v9, s26
    s_nop 0
    v_cndmask_b32 v14, v14, v9, vcc
    v_add_u32 v6, s24, v2
    v_add_u32 v6, 320, v6
    v_mul_u32_u24 v7, 2731, v6
    v_lshrrev_b32 v7, 16, v7
    v_mul_u32_u24 v8, 24, v7
    v_sub_u32 v8, v6, v8
    v_bfe_u32 v9, v7, 1, 1
    v_lshlrev_b32 v9, 2, v9
    v_xor_b32 v8, v8, v9
    v_mul_u32_u24 v9, 37, v8
    v_lshrrev_b32 v9, 8, v9
    v_mul_u32_u24 v16, 7, v9
    v_sub_u32 v16, v8, v16
    v_mul_u32_u24 v7, 2688, v7
    v_mul_u32_u24 v9, 896, v9
    v_add3_u32 v7, v7, v9, s25
    v_lshl_add_u32 v15, v16, 4, v7
    v_cmp_lt_u32 vcc, 20, v8
    v_mov_b32 v9, s26
    s_nop 0
    v_cndmask_b32 v15, v15, v9, vcc
    v_and_b32 v6, 31, v2
    v_lshrrev_b32 v7, 5, v2
    v_bfe_u32 v19, v6, 1, 3
    v_xor_b32 v7, v7, v19
    v_lshlrev_b32 v6, 7, v6
    v_xor_b32 v16, 0, v7
    v_lshl_add_u32 v16, v16, 4, v6
    v_xor_b32 v17, 2, v7
    v_lshl_add_u32 v17, v17, 4, v6
    v_xor_b32 v18, 4, v7
    v_lshl_add_u32 v18, v18, 4, v6
    v_xor_b32 v19, 6, v7
    v_lshl_add_u32 v19, v19, 4, v6
    s_lshl_b32 s24, s22, 13
    v_add_u32 v16, s24, v16
    v_add_u32 v20, 81920, v16
    v_add_u32 v17, s24, v17
    v_add_u32 v21, 81920, v17
    v_add_u32 v18, s24, v18
    v_add_u32 v22, 81920, v18
    v_add_u32 v19, s24, v19
    v_add_u32 v23, 81920, v19
    v_lshrrev_b32 v6, 5, v2
    v_lshlrev_b32 v6, 3, v6
    v_bfe_u32 v7, v2, 2, 2
    v_add_u32 v6, v6, v7
    v_mul_u32_u24 v6, 384, v6
    v_add_u32 v6, 16384, v6
    v_bfe_u32 v7, v2, 4, 1
    v_lshlrev_b32 v7, 5, v7
    v_and_b32 v8, 3, v2
    v_lshl_add_u32 v7, v8, 3, v7
    s_mul_i32 s24, s23, 56
    v_add_u32 v7, s24, v7
    v_bfe_u32 v8, v2, 3, 1
    v_lshlrev_b32 v8, 6, v8
    v_add_u32 v9, 0, v7
    v_xor_b32 v9, v9, v8
    v_add_u32 v24, v9, v6
    v_add_u32 v27, 81920, v24
    v_add_u32 v9, 112, v7
    v_xor_b32 v9, v9, v8
    v_add_u32 v25, v9, v6
    v_add_u32 v28, 81920, v25
    v_add_u32 v9, 224, v7
    v_xor_b32 v9, v9, v8
    v_add_u32 v26, v9, v6
    v_add_u32 v29, 81920, v26
    s_waitcnt lgkmcnt(0)
    s_mov_b32 s4, s36
    s_and_b32 s5, s37, 0xffff
    s_mov_b32 s6, 1835008
    s_mov_b32 s7, 0x00020000
    s_mov_b32 s8, s38
    s_and_b32 s9, s39, 0xffff
    s_mov_b32 s10, 1204224
    s_mov_b32 s11, 0x00020000
    s_mov_b32 s12, s40
    s_and_b32 s13, s41, 0xffff
    s_mov_b32 s14, 6291456
    s_mov_b32 s15, 0x00020000
    s_lshl_b32 s27, s3, 12
    s_mul_i32 s28, s3, 6144
    s_add_u32 m0, s28, 16384
    s_mov_b32 s29, 0
    buffer_load_dwordx4 v10, s[8:11], s29 offen lds
    s_add_u32 m0, s28, 17408
    s_mov_b32 s29, 0
    buffer_load_dwordx4 v11, s[8:11], s29 offen lds
    s_add_u32 m0, s28, 18432
    s_mov_b32 s29, 0
    buffer_load_dwordx4 v12, s[8:11], s29 offen lds
    s_add_u32 m0, s28, 19456
    s_mov_b32 s29, 0
    buffer_load_dwordx4 v13, s[8:11], s29 offen lds
    s_add_u32 m0, s28, 20480
    s_mov_b32 s29, 0
    buffer_load_dwordx4 v14, s[8:11], s29 offen lds
    s_add_u32 m0, s28, 21504
    s_mov_b32 s29, 0
    buffer_load_dwordx4 v15, s[8:11], s29 offen lds
    s_add_u32 m0, s27, 0
    s_mov_b32 s29, 0
    buffer_load_dwordx4 v4, s[4:7], s29 offen lds
    s_add_u32 m0, s27, 1024
    s_mov_b32 s29, 7168
    buffer_load_dwordx4 v5, s[4:7], s29 offen lds
    s_add_u32 m0, s27, 2048
    s_mov_b32 s29, 14336
    buffer_load_dwordx4 v4, s[4:7], s29 offen lds
    s_add_u32 m0, s27, 3072
    s_mov_b32 s29, 21504
    buffer_load_dwordx4 v5, s[4:7], s29 offen lds
    s_add_u32 m0, s28, 57344
    s_mov_b32 s29, 172032
    buffer_load_dwordx4 v10, s[8:11], s29 offen lds
    s_add_u32 m0, s28, 58368
    s_mov_b32 s29, 172032
    buffer_load_dwordx4 v11, s[8:11], s29 offen lds
    s_add_u32 m0, s28, 59392
    s_mov_b32 s29, 172032
    buffer_load_dwordx4 v12, s[8:11], s29 offen lds
    s_add_u32 m0, s28, 60416
    s_mov_b32 s29, 172032
    buffer_load_dwordx4 v13, s[8:11], s29 offen lds
    s_add_u32 m0, s28, 61440
    s_mov_b32 s29, 172032
    buffer_load_dwordx4 v14, s[8:11], s29 offen lds
    s_add_u32 m0, s28, 62464
    s_mov_b32 s29, 172032
    buffer_load_dwordx4 v15, s[8:11], s29 offen lds
    s_add_u32 m0, s27, 40960
    s_mov_b32 s29, 128
    buffer_load_dwordx4 v4, s[4:7], s29 offen lds
    s_add_u32 m0, s27, 41984
    s_mov_b32 s29, 7296
    buffer_load_dwordx4 v5, s[4:7], s29 offen lds
    s_add_u32 m0, s27, 43008
    s_mov_b32 s29, 14464
    buffer_load_dwordx4 v4, s[4:7], s29 offen lds
    s_add_u32 m0, s27, 44032
    s_mov_b32 s29, 21632
    buffer_load_dwordx4 v5, s[4:7], s29 offen lds
    s_lshl_b32 s24, s16, 13
    s_add_u32 s24, s24, 344064
    v_lshlrev_b32 v6, 7, v2
    v_add_u32 v6, s24, v6
    buffer_load_dword v168, v6, s[8:11], 0 offen
    s_and_b32 s24, s16, 7
    s_lshl_b32 s25, s17, 3
    s_add_u32 s24, s24, s25
    s_mul_i32 s24, s24, 57344
    s_lshr_b32 s25, s16, 3
    s_lshl_b32 s25, s25, 7
    s_add_u32 s24, s24, s25
    s_add_u32 s24, s24, 256
    s_cmp_lt_u32 s16, 40
    s_cselect_b32 s24, s24, 0x7ff00000
    v_mul_u32_u24 v6, 896, v2
    v_add_u32 v6, s24, v6
    buffer_load_dword v169, v6, s[4:7], 0 offen
    v_mov_b32 v32, 0
    v_mov_b32 v33, 0
    v_mov_b32 v34, 0
    v_mov_b32 v35, 0
    v_mov_b32 v36, 0
    v_mov_b32 v37, 0
    v_mov_b32 v38, 0
    v_mov_b32 v39, 0
    v_mov_b32 v40, 0
    v_mov_b32 v41, 0
    v_mov_b32 v42, 0
    v_mov_b32 v43, 0
    v_mov_b32 v44, 0
    v_mov_b32 v45, 0
    v_mov_b32 v46, 0
    v_mov_b32 v47, 0
    v_mov_b32 v48, 0
    v_mov_b32 v49, 0
    v_mov_b32 v50, 0
    v_mov_b32 v51, 0
    v_mov_b32 v52, 0
    v_mov_b32 v53, 0
    v_mov_b32 v54, 0
    v_mov_b32 v55, 0
    v_mov_b32 v56, 0
    v_mov_b32 v57, 0
    v_mov_b32 v58, 0
    v_mov_b32 v59, 0
    v_mov_b32 v60, 0
    v_mov_b32 v61, 0
    v_mov_b32 v62, 0
    v_mov_b32 v63, 0
    v_mov_b32 v64, 0
    v_mov_b32 v65, 0
    v_mov_b32 v66, 0
    v_mov_b32 v67, 0
    v_mov_b32 v68, 0
    v_mov_b32 v69, 0
    v_mov_b32 v70, 0
    v_mov_b32 v71, 0
    v_mov_b32 v72, 0
    v_mov_b32 v73, 0
    v_mov_b32 v74, 0
    v_mov_b32 v75, 0
    v_mov_b32 v76, 0
    v_mov_b32 v77, 0
    v_mov_b32 v78, 0
    v_mov_b32 v79, 0
    v_mov_b32 v80, 0
    v_mov_b32 v81, 0
    v_mov_b32 v82, 0
    v_mov_b32 v83, 0
    v_mov_b32 v84, 0
    v_mov_b32 v85, 0
    v_mov_b32 v86, 0
    v_mov_b32 v87, 0
    v_mov_b32 v88, 0
    v_mov_b32 v89, 0
    v_mov_b32 v90, 0
    v_mov_b32 v91, 0
    v_mov_b32 v92, 0
    v_mov_b32 v93, 0
    v_mov_b32 v94, 0
    v_mov_b32 v95, 0
    v_mov_b32 v96, 0
    v_mov_b32 v97, 0
    v_mov_b32 v98, 0
    v_mov_b32 v99, 0
    v_mov_b32 v100, 0
    v_mov_b32 v101, 0
    v_mov_b32 v102, 0
    v_mov_b32 v103, 0
    v_mov_b32 v104, 0
    v_mov_b32 v105, 0
    v_mov_b32 v106, 0
    v_mov_b32 v107, 0
    v_mov_b32 v108, 0
    v_mov_b32 v109, 0
    v_mov_b32 v110, 0
    v_mov_b32 v111, 0
    v_mov_b32 v112, 0
    v_mov_b32 v113, 0
    v_mov_b32 v114, 0
    v_mov_b32 v115, 0
    v_mov_b32 v116, 0
    v_mov_b32 v117, 0
    v_mov_b32 v118, 0
    v_mov_b32 v119, 0
    v_mov_b32 v120, 0
    v_mov_b32 v121, 0
    v_mov_b32 v122, 0
    v_mov_b32 v123, 0
    v_mov_b32 v124, 0
    v_mov_b32 v125, 0
    v_mov_b32 v126, 0
    v_mov_b32 v127, 0
    s_waitcnt vmcnt(12)
    s_barrier
    ds_read_b128 v[128:131], v16 offset:0
    ds_read_b128 v[132:135], v16 offset:4096
    ds_read_b64_tr_b16 v[144:145], v24 offset:0
    ds_read_b64_tr_b16 v[146:147], v24 offset:1536
    ds_read_b64_tr_b16 v[148:149], v25 offset:0
    ds_read_b64_tr_b16 v[150:151], v25 offset:1536
    ds_read_b64_tr_b16 v[152:153], v26 offset:0
    ds_read_b64_tr_b16 v[154:155], v26 offset:1536
    ds_read_b128 v[136:139], v17 offset:0
    ds_read_b128 v[140:143], v17 offset:4096
    ds_read_b64_tr_b16 v[156:157], v24 offset:6144
    ds_read_b64_tr_b16 v[158:159], v24 offset:7680
    ds_read_b64_tr_b16 v[160:161], v25 offset:6144
    ds_read_b64_tr_b16 v[162:163], v25 offset:7680
    ds_read_b64_tr_b16 v[164:165], v26 offset:6144
    ds_read_b64_tr_b16 v[166:167], v26 offset:7680
    s_waitcnt lgkmcnt(8)
    v_mfma_f32_32x32x16_bf16 v[32:47], v[144:147], v[128:131], v[32:47]
    s_add_u32 m0, s28, 98304
    s_mov_b32 s29, 344064
    buffer_load_dwordx4 v10, s[8:11], s29 offen lds
    v_mfma_f32_32x32x16_bf16 v[48:63], v[148:151], v[128:131], v[48:63]
    s_add_u32 m0, s28, 99328
    s_mov_b32 s29, 344064
    buffer_load_dwordx4 v11, s[8:11], s29 offen lds
    v_mfma_f32_32x32x16_bf16 v[64:79], v[128:131], v[152:155], v[64:79]
    s_add_u32 m0, s28, 100352
    s_mov_b32 s29, 344064
    buffer_load_dwordx4 v12, s[8:11], s29 offen lds
    v_mfma_f32_32x32x16_bf16 v[80:95], v[144:147], v[132:135], v[80:95]
    v_mfma_f32_32x32x16_bf16 v[96:111], v[148:151], v[132:135], v[96:111]
    v_mfma_f32_32x32x16_bf16 v[112:127], v[132:135], v[152:155], v[112:127]
    ds_read_b128 v[128:131], v18 offset:0
    ds_read_b128 v[132:135], v18 offset:4096
    ds_read_b64_tr_b16 v[144:145], v24 offset:12288
    ds_read_b64_tr_b16 v[146:147], v24 offset:13824
    ds_read_b64_tr_b16 v[148:149], v25 offset:12288
    ds_read_b64_tr_b16 v[150:151], v25 offset:13824
    ds_read_b64_tr_b16 v[152:153], v26 offset:12288
    ds_read_b64_tr_b16 v[154:155], v26 offset:13824
    s_waitcnt lgkmcnt(8)
    v_mfma_f32_32x32x16_bf16 v[32:47], v[156:159], v[136:139], v[32:47]
    s_add_u32 m0, s28, 101376
    s_mov_b32 s29, 344064
    buffer_load_dwordx4 v13, s[8:11], s29 offen lds
    v_mfma_f32_32x32x16_bf16 v[48:63], v[160:163], v[136:139], v[48:63]
    s_add_u32 m0, s28, 102400
    s_mov_b32 s29, 344064
    buffer_load_dwordx4 v14, s[8:11], s29 offen lds
    v_mfma_f32_32x32x16_bf16 v[64:79], v[136:139], v[164:167], v[64:79]
    s_add_u32 m0, s28, 103424
    s_mov_b32 s29, 344064
    buffer_load_dwordx4 v15, s[8:11], s29 offen lds
    v_mfma_f32_32x32x16_bf16 v[80:95], v[156:159], v[140:143], v[80:95]
    v_mfma_f32_32x32x16_bf16 v[96:111], v[160:163], v[140:143], v[96:111]
    v_mfma_f32_32x32x16_bf16 v[112:127], v[140:143], v[164:167], v[112:127]
    ds_read_b128 v[136:139], v19 offset:0
    ds_read_b128 v[140:143], v19 offset:4096
    ds_read_b64_tr_b16 v[156:157], v24 offset:18432
    ds_read_b64_tr_b16 v[158:159], v24 offset:19968
    ds_read_b64_tr_b16 v[160:161], v25 offset:18432
    ds_read_b64_tr_b16 v[162:163], v25 offset:19968
    ds_read_b64_tr_b16 v[164:165], v26 offset:18432
    ds_read_b64_tr_b16 v[166:167], v26 offset:19968
    s_waitcnt lgkmcnt(8)
    v_mfma_f32_32x32x16_bf16 v[32:47], v[144:147], v[128:131], v[32:47]
    s_add_u32 m0, s27, 81920
    s_mov_b32 s29, 256
    buffer_load_dwordx4 v4, s[4:7], s29 offen lds
    v_mfma_f32_32x32x16_bf16 v[48:63], v[148:151], v[128:131], v[48:63]
    s_add_u32 m0, s27, 82944
    s_mov_b32 s29, 7424
    buffer_load_dwordx4 v5, s[4:7], s29 offen lds
    v_mfma_f32_32x32x16_bf16 v[64:79], v[128:131], v[152:155], v[64:79]
    v_mfma_f32_32x32x16_bf16 v[80:95], v[144:147], v[132:135], v[80:95]
    v_mfma_f32_32x32x16_bf16 v[96:111], v[148:151], v[132:135], v[96:111]
    v_mfma_f32_32x32x16_bf16 v[112:127], v[132:135], v[152:155], v[112:127]
    s_waitcnt lgkmcnt(0)
    v_mfma_f32_32x32x16_bf16 v[32:47], v[156:159], v[136:139], v[32:47]
    s_add_u32 m0, s27, 83968
    s_mov_b32 s29, 14592
    buffer_load_dwordx4 v4, s[4:7], s29 offen lds
    v_mfma_f32_32x32x16_bf16 v[48:63], v[160:163], v[136:139], v[48:63]
    s_add_u32 m0, s27, 84992
    s_mov_b32 s29, 21760
    buffer_load_dwordx4 v5, s[4:7], s29 offen lds
    v_mfma_f32_32x32x16_bf16 v[64:79], v[136:139], v[164:167], v[64:79]
    v_mfma_f32_32x32x16_bf16 v[80:95], v[156:159], v[140:143], v[80:95]
    v_mfma_f32_32x32x16_bf16 v[96:111], v[160:163], v[140:143], v[96:111]
    v_mfma_f32_32x32x16_bf16 v[112:127], v[140:143], v[164:167], v[112:127]
    s_waitcnt vmcnt(12)
    s_barrier
    ds_read_b128 v[128:131], v16 offset:40960
    ds_read_b128 v[132:135], v16 offset:45056
    ds_read_b64_tr_b16 v[144:145], v24 offset:40960
    ds_read_b64_tr_b16 v[146:147], v24 offset:42496
    ds_read_b64_tr_b16 v[148:149], v25 offset:40960
    ds_read_b64_tr_b16 v[150:151], v25 offset:42496
    ds_read_b64_tr_b16 v[152:153], v26 offset:40960
    ds_read_b64_tr_b16 v[154:155], v26 offset:42496
    ds_read_b128 v[136:139], v17 offset:40960
    ds_read_b128 v[140:143], v17 offset:45056
    ds_read_b64_tr_b16 v[156:157], v24 offset:47104
    ds_read_b64_tr_b16 v[158:159], v24 offset:48640
    ds_read_b64_tr_b16 v[160:161], v25 offset:47104
    ds_read_b64_tr_b16 v[162:163], v25 offset:48640
    ds_read_b64_tr_b16 v[164:165], v26 offset:47104
    ds_read_b64_tr_b16 v[166:167], v26 offset:48640
    s_waitcnt lgkmcnt(8)
    v_mfma_f32_32x32x16_bf16 v[32:47], v[144:147], v[128:131], v[32:47]
    s_add_u32 m0, s28, 16384
    s_mov_b32 s29, 516096
    buffer_load_dwordx4 v10, s[8:11], s29 offen lds
    v_mfma_f32_32x32x16_bf16 v[48:63], v[148:151], v[128:131], v[48:63]
    s_add_u32 m0, s28, 17408
    s_mov_b32 s29, 516096
    buffer_load_dwordx4 v11, s[8:11], s29 offen lds
    v_mfma_f32_32x32x16_bf16 v[64:79], v[128:131], v[152:155], v[64:79]
    s_add_u32 m0, s28, 18432
    s_mov_b32 s29, 516096
    buffer_load_dwordx4 v12, s[8:11], s29 offen lds
    v_mfma_f32_32x32x16_bf16 v[80:95], v[144:147], v[132:135], v[80:95]
    v_mfma_f32_32x32x16_bf16 v[96:111], v[148:151], v[132:135], v[96:111]
    v_mfma_f32_32x32x16_bf16 v[112:127], v[132:135], v[152:155], v[112:127]
    ds_read_b128 v[128:131], v18 offset:40960
    ds_read_b128 v[132:135], v18 offset:45056
    ds_read_b64_tr_b16 v[144:145], v24 offset:53248
    ds_read_b64_tr_b16 v[146:147], v24 offset:54784
    ds_read_b64_tr_b16 v[148:149], v25 offset:53248
    ds_read_b64_tr_b16 v[150:151], v25 offset:54784
    ds_read_b64_tr_b16 v[152:153], v26 offset:53248
    ds_read_b64_tr_b16 v[154:155], v26 offset:54784
    s_waitcnt lgkmcnt(8)
    v_mfma_f32_32x32x16_bf16 v[32:47], v[156:159], v[136:139], v[32:47]
    s_add_u32 m0, s28, 19456
    s_mov_b32 s29, 516096
    buffer_load_dwordx4 v13, s[8:11], s29 offen lds
    v_mfma_f32_32x32x16_bf16 v[48:63], v[160:163], v[136:139], v[48:63]
    s_add_u32 m0, s28, 20480
    s_mov_b32 s29, 516096
    buffer_load_dwordx4 v14, s[8:11], s29 offen lds
    v_mfma_f32_32x32x16_bf16 v[64:79], v[136:139], v[164:167], v[64:79]
    s_add_u32 m0, s28, 21504
    s_mov_b32 s29, 516096
    buffer_load_dwordx4 v15, s[8:11], s29 offen lds
    v_mfma_f32_32x32x16_bf16 v[80:95], v[156:159], v[140:143], v[80:95]
    v_mfma_f32_32x32x16_bf16 v[96:111], v[160:163], v[140:143], v[96:111]
    v_mfma_f32_32x32x16_bf16 v[112:127], v[140:143], v[164:167], v[112:127]
    ds_read_b128 v[136:139], v19 offset:40960
    ds_read_b128 v[140:143], v19 offset:45056
    ds_read_b64_tr_b16 v[156:157], v24 offset:59392
    ds_read_b64_tr_b16 v[158:159], v24 offset:60928
    ds_read_b64_tr_b16 v[160:161], v25 offset:59392
    ds_read_b64_tr_b16 v[162:163], v25 offset:60928
    ds_read_b64_tr_b16 v[164:165], v26 offset:59392
    ds_read_b64_tr_b16 v[166:167], v26 offset:60928
    s_waitcnt lgkmcnt(8)
    v_mfma_f32_32x32x16_bf16 v[32:47], v[144:147], v[128:131], v[32:47]
    s_add_u32 m0, s27, 0
    s_mov_b32 s29, 384
    buffer_load_dwordx4 v4, s[4:7], s29 offen lds
    v_mfma_f32_32x32x16_bf16 v[48:63], v[148:151], v[128:131], v[48:63]
    s_add_u32 m0, s27, 1024
    s_mov_b32 s29, 7552
    buffer_load_dwordx4 v5, s[4:7], s29 offen lds
    v_mfma_f32_32x32x16_bf16 v[64:79], v[128:131], v[152:155], v[64:79]
    v_mfma_f32_32x32x16_bf16 v[80:95], v[144:147], v[132:135], v[80:95]
    v_mfma_f32_32x32x16_bf16 v[96:111], v[148:151], v[132:135], v[96:111]
    v_mfma_f32_32x32x16_bf16 v[112:127], v[132:135], v[152:155], v[112:127]
    s_waitcnt lgkmcnt(0)
    v_mfma_f32_32x32x16_bf16 v[32:47], v[156:159], v[136:139], v[32:47]
    s_add_u32 m0, s27, 2048
    s_mov_b32 s29, 14720
    buffer_load_dwordx4 v4, s[4:7], s29 offen lds
    v_mfma_f32_32x32x16_bf16 v[48:63], v[160:163], v[136:139], v[48:63]
    s_add_u32 m0, s27, 3072
    s_mov_b32 s29, 21888
    buffer_load_dwordx4 v5, s[4:7], s29 offen lds
    v_mfma_f32_32x32x16_bf16 v[64:79], v[136:139], v[164:167], v[64:79]
    v_mfma_f32_32x32x16_bf16 v[80:95], v[156:159], v[140:143], v[80:95]
    v_mfma_f32_32x32x16_bf16 v[96:111], v[160:163], v[140:143], v[96:111]
    v_mfma_f32_32x32x16_bf16 v[112:127], v[140:143], v[164:167], v[112:127]
    s_waitcnt vmcnt(10)
    s_barrier
    ds_read_b128 v[128:131], v20 offset:0
    ds_read_b128 v[132:135], v20 offset:4096
    ds_read_b64_tr_b16 v[144:145], v27 offset:0
    ds_read_b64_tr_b16 v[146:147], v27 offset:1536
    ds_read_b64_tr_b16 v[148:149], v28 offset:0
    ds_read_b64_tr_b16 v[150:151], v28 offset:1536
    ds_read_b64_tr_b16 v[152:153], v29 offset:0
    ds_read_b64_tr_b16 v[154:155], v29 offset:1536
    ds_read_b128 v[136:139], v21 offset:0
    ds_read_b128 v[140:143], v21 offset:4096
    ds_read_b64_tr_b16 v[156:157], v27 offset:6144
    ds_read_b64_tr_b16 v[158:159], v27 offset:7680
    ds_read_b64_tr_b16 v[160:161], v28 offset:6144
    ds_read_b64_tr_b16 v[162:163], v28 offset:7680
    ds_read_b64_tr_b16 v[164:165], v29 offset:6144
    ds_read_b64_tr_b16 v[166:167], v29 offset:7680
    s_waitcnt lgkmcnt(8)
    v_mfma_f32_32x32x16_bf16 v[32:47], v[144:147], v[128:131], v[32:47]
    s_add_u32 m0, s28, 57344
    s_mov_b32 s29, 688128
    buffer_load_dwordx4 v10, s[8:11], s29 offen lds
    v_mfma_f32_32x32x16_bf16 v[48:63], v[148:151], v[128:131], v[48:63]
    s_add_u32 m0, s28, 58368
    s_mov_b32 s29, 688128
    buffer_load_dwordx4 v11, s[8:11], s29 offen lds
    v_mfma_f32_32x32x16_bf16 v[64:79], v[128:131], v[152:155], v[64:79]
    s_add_u32 m0, s28, 59392
    s_mov_b32 s29, 688128
    buffer_load_dwordx4 v12, s[8:11], s29 offen lds
    v_mfma_f32_32x32x16_bf16 v[80:95], v[144:147], v[132:135], v[80:95]
    v_mfma_f32_32x32x16_bf16 v[96:111], v[148:151], v[132:135], v[96:111]
    v_mfma_f32_32x32x16_bf16 v[112:127], v[132:135], v[152:155], v[112:127]
    ds_read_b128 v[128:131], v22 offset:0
    ds_read_b128 v[132:135], v22 offset:4096
    ds_read_b64_tr_b16 v[144:145], v27 offset:12288
    ds_read_b64_tr_b16 v[146:147], v27 offset:13824
    ds_read_b64_tr_b16 v[148:149], v28 offset:12288
    ds_read_b64_tr_b16 v[150:151], v28 offset:13824
    ds_read_b64_tr_b16 v[152:153], v29 offset:12288
    ds_read_b64_tr_b16 v[154:155], v29 offset:13824
    s_waitcnt lgkmcnt(8)
    v_mfma_f32_32x32x16_bf16 v[32:47], v[156:159], v[136:139], v[32:47]
    s_add_u32 m0, s28, 60416
    s_mov_b32 s29, 688128
    buffer_load_dwordx4 v13, s[8:11], s29 offen lds
    v_mfma_f32_32x32x16_bf16 v[48:63], v[160:163], v[136:139], v[48:63]
    s_add_u32 m0, s28, 61440
    s_mov_b32 s29, 688128
    buffer_load_dwordx4 v14, s[8:11], s29 offen lds
    v_mfma_f32_32x32x16_bf16 v[64:79], v[136:139], v[164:167], v[64:79]
    s_add_u32 m0, s28, 62464
    s_mov_b32 s29, 688128
    buffer_load_dwordx4 v15, s[8:11], s29 offen lds
    v_mfma_f32_32x32x16_bf16 v[80:95], v[156:159], v[140:143], v[80:95]
    v_mfma_f32_32x32x16_bf16 v[96:111], v[160:163], v[140:143], v[96:111]
    v_mfma_f32_32x32x16_bf16 v[112:127], v[140:143], v[164:167], v[112:127]
    ds_read_b128 v[136:139], v23 offset:0
    ds_read_b128 v[140:143], v23 offset:4096
    ds_read_b64_tr_b16 v[156:157], v27 offset:18432
    ds_read_b64_tr_b16 v[158:159], v27 offset:19968
    ds_read_b64_tr_b16 v[160:161], v28 offset:18432
    ds_read_b64_tr_b16 v[162:163], v28 offset:19968
    ds_read_b64_tr_b16 v[164:165], v29 offset:18432
    ds_read_b64_tr_b16 v[166:167], v29 offset:19968
    s_waitcnt lgkmcnt(8)
    v_mfma_f32_32x32x16_bf16 v[32:47], v[144:147], v[128:131], v[32:47]
    s_add_u32 m0, s27, 40960
    s_mov_b32 s29, 512
    buffer_load_dwordx4 v4, s[4:7], s29 offen lds
    v_mfma_f32_32x32x16_bf16 v[48:63], v[148:151], v[128:131], v[48:63]
    s_add_u32 m0, s27, 41984
    s_mov_b32 s29, 7680
    buffer_load_dwordx4 v5, s[4:7], s29 offen lds
    v_mfma_f32_32x32x16_bf16 v[64:79], v[128:131], v[152:155], v[64:79]
    v_mfma_f32_32x32x16_bf16 v[80:95], v[144:147], v[132:135], v[80:95]
    v_mfma_f32_32x32x16_bf16 v[96:111], v[148:151], v[132:135], v[96:111]
    v_mfma_f32_32x32x16_bf16 v[112:127], v[132:135], v[152:155], v[112:127]
    s_waitcnt lgkmcnt(0)
    v_mfma_f32_32x32x16_bf16 v[32:47], v[156:159], v[136:139], v[32:47]
    s_add_u32 m0, s27, 43008
    s_mov_b32 s29, 14848
    buffer_load_dwordx4 v4, s[4:7], s29 offen lds
    v_mfma_f32_32x32x16_bf16 v[48:63], v[160:163], v[136:139], v[48:63]
    s_add_u32 m0, s27, 44032
    s_mov_b32 s29, 22016
    buffer_load_dwordx4 v5, s[4:7], s29 offen lds
    v_mfma_f32_32x32x16_bf16 v[64:79], v[136:139], v[164:167], v[64:79]
    v_mfma_f32_32x32x16_bf16 v[80:95], v[156:159], v[140:143], v[80:95]
    v_mfma_f32_32x32x16_bf16 v[96:111], v[160:163], v[140:143], v[96:111]
    v_mfma_f32_32x32x16_bf16 v[112:127], v[140:143], v[164:167], v[112:127]
    s_waitcnt vmcnt(10)
    s_barrier
    ds_read_b128 v[128:131], v16 offset:0
    ds_read_b128 v[132:135], v16 offset:4096
    ds_read_b64_tr_b16 v[144:145], v24 offset:0
    ds_read_b64_tr_b16 v[146:147], v24 offset:1536
    ds_read_b64_tr_b16 v[148:149], v25 offset:0
    ds_read_b64_tr_b16 v[150:151], v25 offset:1536
    ds_read_b64_tr_b16 v[152:153], v26 offset:0
    ds_read_b64_tr_b16 v[154:155], v26 offset:1536
    ds_read_b128 v[136:139], v17 offset:0
    ds_read_b128 v[140:143], v17 offset:4096
    ds_read_b64_tr_b16 v[156:157], v24 offset:6144
    ds_read_b64_tr_b16 v[158:159], v24 offset:7680
    ds_read_b64_tr_b16 v[160:161], v25 offset:6144
    ds_read_b64_tr_b16 v[162:163], v25 offset:7680
    ds_read_b64_tr_b16 v[164:165], v26 offset:6144
    ds_read_b64_tr_b16 v[166:167], v26 offset:7680
    s_waitcnt lgkmcnt(8)
    v_mfma_f32_32x32x16_bf16 v[32:47], v[144:147], v[128:131], v[32:47]
    s_add_u32 m0, s28, 98304
    s_mov_b32 s29, 860160
    buffer_load_dwordx4 v10, s[8:11], s29 offen lds
    v_mfma_f32_32x32x16_bf16 v[48:63], v[148:151], v[128:131], v[48:63]
    s_add_u32 m0, s28, 99328
    s_mov_b32 s29, 860160
    buffer_load_dwordx4 v11, s[8:11], s29 offen lds
    v_mfma_f32_32x32x16_bf16 v[64:79], v[128:131], v[152:155], v[64:79]
    s_add_u32 m0, s28, 100352
    s_mov_b32 s29, 860160
    buffer_load_dwordx4 v12, s[8:11], s29 offen lds
    v_mfma_f32_32x32x16_bf16 v[80:95], v[144:147], v[132:135], v[80:95]
    v_mfma_f32_32x32x16_bf16 v[96:111], v[148:151], v[132:135], v[96:111]
    v_mfma_f32_32x32x16_bf16 v[112:127], v[132:135], v[152:155], v[112:127]
    ds_read_b128 v[128:131], v18 offset:0
    ds_read_b128 v[132:135], v18 offset:4096
    ds_read_b64_tr_b16 v[144:145], v24 offset:12288
    ds_read_b64_tr_b16 v[146:147], v24 offset:13824
    ds_read_b64_tr_b16 v[148:149], v25 offset:12288
    ds_read_b64_tr_b16 v[150:151], v25 offset:13824
    ds_read_b64_tr_b16 v[152:153], v26 offset:12288
    ds_read_b64_tr_b16 v[154:155], v26 offset:13824
    s_waitcnt lgkmcnt(8)
    v_mfma_f32_32x32x16_bf16 v[32:47], v[156:159], v[136:139], v[32:47]
    s_add_u32 m0, s28, 101376
    s_mov_b32 s29, 860160
    buffer_load_dwordx4 v13, s[8:11], s29 offen lds
    v_mfma_f32_32x32x16_bf16 v[48:63], v[160:163], v[136:139], v[48:63]
    s_add_u32 m0, s28, 102400
    s_mov_b32 s29, 860160
    buffer_load_dwordx4 v14, s[8:11], s29 offen lds
    v_mfma_f32_32x32x16_bf16 v[64:79], v[136:139], v[164:167], v[64:79]
    s_add_u32 m0, s28, 103424
    s_mov_b32 s29, 860160
    buffer_load_dwordx4 v15, s[8:11], s29 offen lds
    v_mfma_f32_32x32x16_bf16 v[80:95], v[156:159], v[140:143], v[80:95]
    v_mfma_f32_32x32x16_bf16 v[96:111], v[160:163], v[140:143], v[96:111]
    v_mfma_f32_32x32x16_bf16 v[112:127], v[140:143], v[164:167], v[112:127]
    ds_read_b128 v[136:139], v19 offset:0
    ds_read_b128 v[140:143], v19 offset:4096
    ds_read_b64_tr_b16 v[156:157], v24 offset:18432
    ds_read_b64_tr_b16 v[158:159], v24 offset:19968
    ds_read_b64_tr_b16 v[160:161], v25 offset:18432
    ds_read_b64_tr_b16 v[162:163], v25 offset:19968
    ds_read_b64_tr_b16 v[164:165], v26 offset:18432
    ds_read_b64_tr_b16 v[166:167], v26 offset:19968
    s_waitcnt lgkmcnt(8)
    v_mfma_f32_32x32x16_bf16 v[32:47], v[144:147], v[128:131], v[32:47]
    s_add_u32 m0, s27, 81920
    s_mov_b32 s29, 640
    buffer_load_dwordx4 v4, s[4:7], s29 offen lds
    v_mfma_f32_32x32x16_bf16 v[48:63], v[148:151], v[128:131], v[48:63]
    s_add_u32 m0, s27, 82944
    s_mov_b32 s29, 7808
    buffer_load_dwordx4 v5, s[4:7], s29 offen lds
    v_mfma_f32_32x32x16_bf16 v[64:79], v[128:131], v[152:155], v[64:79]
    v_mfma_f32_32x32x16_bf16 v[80:95], v[144:147], v[132:135], v[80:95]
    v_mfma_f32_32x32x16_bf16 v[96:111], v[148:151], v[132:135], v[96:111]
    v_mfma_f32_32x32x16_bf16 v[112:127], v[132:135], v[152:155], v[112:127]
    s_waitcnt lgkmcnt(0)
    v_mfma_f32_32x32x16_bf16 v[32:47], v[156:159], v[136:139], v[32:47]
    s_add_u32 m0, s27, 83968
    s_mov_b32 s29, 14976
    buffer_load_dwordx4 v4, s[4:7], s29 offen lds
    v_mfma_f32_32x32x16_bf16 v[48:63], v[160:163], v[136:139], v[48:63]
    s_add_u32 m0, s27, 84992
    s_mov_b32 s29, 22144
    buffer_load_dwordx4 v5, s[4:7], s29 offen lds
    v_mfma_f32_32x32x16_bf16 v[64:79], v[136:139], v[164:167], v[64:79]
    v_mfma_f32_32x32x16_bf16 v[80:95], v[156:159], v[140:143], v[80:95]
    v_mfma_f32_32x32x16_bf16 v[96:111], v[160:163], v[140:143], v[96:111]
    v_mfma_f32_32x32x16_bf16 v[112:127], v[140:143], v[164:167], v[112:127]
    s_waitcnt vmcnt(10)
    s_barrier
    ds_read_b128 v[128:131], v16 offset:40960
    ds_read_b128 v[132:135], v16 offset:45056
    ds_read_b64_tr_b16 v[144:145], v24 offset:40960
    ds_read_b64_tr_b16 v[146:147], v24 offset:42496
    ds_read_b64_tr_b16 v[148:149], v25 offset:40960
    ds_read_b64_tr_b16 v[150:151], v25 offset:42496
    ds_read_b64_tr_b16 v[152:153], v26 offset:40960
    ds_read_b64_tr_b16 v[154:155], v26 offset:42496
    ds_read_b128 v[136:139], v17 offset:40960
    ds_read_b128 v[140:143], v17 offset:45056
    ds_read_b64_tr_b16 v[156:157], v24 offset:47104
    ds_read_b64_tr_b16 v[158:159], v24 offset:48640
    ds_read_b64_tr_b16 v[160:161], v25 offset:47104
    ds_read_b64_tr_b16 v[162:163], v25 offset:48640
    ds_read_b64_tr_b16 v[164:165], v26 offset:47104
    ds_read_b64_tr_b16 v[166:167], v26 offset:48640
    s_waitcnt lgkmcnt(8)
    v_mfma_f32_32x32x16_bf16 v[32:47], v[144:147], v[128:131], v[32:47]
    s_add_u32 m0, s28, 16384
    s_mov_b32 s29, 1032192
    buffer_load_dwordx4 v10, s[8:11], s29 offen lds
    v_mfma_f32_32x32x16_bf16 v[48:63], v[148:151], v[128:131], v[48:63]
    s_add_u32 m0, s28, 17408
    s_mov_b32 s29, 1032192
    buffer_load_dwordx4 v11, s[8:11], s29 offen lds
    v_mfma_f32_32x32x16_bf16 v[64:79], v[128:131], v[152:155], v[64:79]
    s_add_u32 m0, s28, 18432
    s_mov_b32 s29, 1032192
    buffer_load_dwordx4 v12, s[8:11], s29 offen lds
    v_mfma_f32_32x32x16_bf16 v[80:95], v[144:147], v[132:135], v[80:95]
    v_mfma_f32_32x32x16_bf16 v[96:111], v[148:151], v[132:135], v[96:111]
    v_mfma_f32_32x32x16_bf16 v[112:127], v[132:135], v[152:155], v[112:127]
    ds_read_b128 v[128:131], v18 offset:40960
    ds_read_b128 v[132:135], v18 offset:45056
    ds_read_b64_tr_b16 v[144:145], v24 offset:53248
    ds_read_b64_tr_b16 v[146:147], v24 offset:54784
    ds_read_b64_tr_b16 v[148:149], v25 offset:53248
    ds_read_b64_tr_b16 v[150:151], v25 offset:54784
    ds_read_b64_tr_b16 v[152:153], v26 offset:53248
    ds_read_b64_tr_b16 v[154:155], v26 offset:54784
    s_waitcnt lgkmcnt(8)
    v_mfma_f32_32x32x16_bf16 v[32:47], v[156:159], v[136:139], v[32:47]
    s_add_u32 m0, s28, 19456
    s_mov_b32 s29, 1032192
    buffer_load_dwordx4 v13, s[8:11], s29 offen lds
    v_mfma_f32_32x32x16_bf16 v[48:63], v[160:163], v[136:139], v[48:63]
    s_add_u32 m0, s28, 20480
    s_mov_b32 s29, 1032192
    buffer_load_dwordx4 v14, s[8:11], s29 offen lds
    v_mfma_f32_32x32x16_bf16 v[64:79], v[136:139], v[164:167], v[64:79]
    s_add_u32 m0, s28, 21504
    s_mov_b32 s29, 1032192
    buffer_load_dwordx4 v15, s[8:11], s29 offen lds
    v_mfma_f32_32x32x16_bf16 v[80:95], v[156:159], v[140:143], v[80:95]
    v_mfma_f32_32x32x16_bf16 v[96:111], v[160:163], v[140:143], v[96:111]
    v_mfma_f32_32x32x16_bf16 v[112:127], v[140:143], v[164:167], v[112:127]
    ds_read_b128 v[136:139], v19 offset:40960
    ds_read_b128 v[140:143], v19 offset:45056
    ds_read_b64_tr_b16 v[156:157], v24 offset:59392
    ds_read_b64_tr_b16 v[158:159], v24 offset:60928
    ds_read_b64_tr_b16 v[160:161], v25 offset:59392
    ds_read_b64_tr_b16 v[162:163], v25 offset:60928
    ds_read_b64_tr_b16 v[164:165], v26 offset:59392
    ds_read_b64_tr_b16 v[166:167], v26 offset:60928
    s_waitcnt lgkmcnt(8)
    v_mfma_f32_32x32x16_bf16 v[32:47], v[144:147], v[128:131], v[32:47]
    s_add_u32 m0, s27, 0
    s_mov_b32 s29, 768
    buffer_load_dwordx4 v4, s[4:7], s29 offen lds
    v_mfma_f32_32x32x16_bf16 v[48:63], v[148:151], v[128:131], v[48:63]
    s_add_u32 m0, s27, 1024
    s_mov_b32 s29, 7936
    buffer_load_dwordx4 v5, s[4:7], s29 offen lds
    v_mfma_f32_32x32x16_bf16 v[64:79], v[128:131], v[152:155], v[64:79]
    v_mfma_f32_32x32x16_bf16 v[80:95], v[144:147], v[132:135], v[80:95]
    v_mfma_f32_32x32x16_bf16 v[96:111], v[148:151], v[132:135], v[96:111]
    v_mfma_f32_32x32x16_bf16 v[112:127], v[132:135], v[152:155], v[112:127]
    s_waitcnt lgkmcnt(0)
    v_mfma_f32_32x32x16_bf16 v[32:47], v[156:159], v[136:139], v[32:47]
    s_add_u32 m0, s27, 2048
    s_mov_b32 s29, 15104
    buffer_load_dwordx4 v4, s[4:7], s29 offen lds
    v_mfma_f32_32x32x16_bf16 v[48:63], v[160:163], v[136:139], v[48:63]
    s_add_u32 m0, s27, 3072
    s_mov_b32 s29, 22272
    buffer_load_dwordx4 v5, s[4:7], s29 offen lds
    v_mfma_f32_32x32x16_bf16 v[64:79], v[136:139], v[164:167], v[64:79]
    v_mfma_f32_32x32x16_bf16 v[80:95], v[156:159], v[140:143], v[80:95]
    v_mfma_f32_32x32x16_bf16 v[96:111], v[160:163], v[140:143], v[96:111]
    v_mfma_f32_32x32x16_bf16 v[112:127], v[140:143], v[164:167], v[112:127]
    s_waitcnt vmcnt(10)
    s_barrier
    ds_read_b128 v[128:131], v20 offset:0
    ds_read_b128 v[132:135], v20 offset:4096
    ds_read_b64_tr_b16 v[144:145], v27 offset:0
    ds_read_b64_tr_b16 v[146:147], v27 offset:1536
    ds_read_b64_tr_b16 v[148:149], v28 offset:0
    ds_read_b64_tr_b16 v[150:151], v28 offset:1536
    ds_read_b64_tr_b16 v[152:153], v29 offset:0
    ds_read_b64_tr_b16 v[154:155], v29 offset:1536
    ds_read_b128 v[136:139], v21 offset:0
    ds_read_b128 v[140:143], v21 offset:4096
    ds_read_b64_tr_b16 v[156:157], v27 offset:6144
    ds_read_b64_tr_b16 v[158:159], v27 offset:7680
    ds_read_b64_tr_b16 v[160:161], v28 offset:6144
    ds_read_b64_tr_b16 v[162:163], v28 offset:7680
    ds_read_b64_tr_b16 v[164:165], v29 offset:6144
    ds_read_b64_tr_b16 v[166:167], v29 offset:7680
    s_waitcnt lgkmcnt(8)
    v_mfma_f32_32x32x16_bf16 v[32:47], v[144:147], v[128:131], v[32:47]
    v_mfma_f32_32x32x16_bf16 v[48:63], v[148:151], v[128:131], v[48:63]
    v_mfma_f32_32x32x16_bf16 v[64:79], v[128:131], v[152:155], v[64:79]
    v_mfma_f32_32x32x16_bf16 v[80:95], v[144:147], v[132:135], v[80:95]
    v_mfma_f32_32x32x16_bf16 v[96:111], v[148:151], v[132:135], v[96:111]
    v_mfma_f32_32x32x16_bf16 v[112:127], v[132:135], v[152:155], v[112:127]
    ds_read_b128 v[128:131], v22 offset:0
    ds_read_b128 v[132:135], v22 offset:4096
    ds_read_b64_tr_b16 v[144:145], v27 offset:12288
    ds_read_b64_tr_b16 v[146:147], v27 offset:13824
    ds_read_b64_tr_b16 v[148:149], v28 offset:12288
    ds_read_b64_tr_b16 v[150:151], v28 offset:13824
    ds_read_b64_tr_b16 v[152:153], v29 offset:12288
    ds_read_b64_tr_b16 v[154:155], v29 offset:13824
    s_waitcnt lgkmcnt(8)
    v_mfma_f32_32x32x16_bf16 v[32:47], v[156:159], v[136:139], v[32:47]
    v_mfma_f32_32x32x16_bf16 v[48:63], v[160:163], v[136:139], v[48:63]
    v_mfma_f32_32x32x16_bf16 v[64:79], v[136:139], v[164:167], v[64:79]
    v_mfma_f32_32x32x16_bf16 v[80:95], v[156:159], v[140:143], v[80:95]
    v_mfma_f32_32x32x16_bf16 v[96:111], v[160:163], v[140:143], v[96:111]
    v_mfma_f32_32x32x16_bf16 v[112:127], v[140:143], v[164:167], v[112:127]
    ds_read_b128 v[136:139], v23 offset:0
    ds_read_b128 v[140:143], v23 offset:4096
    ds_read_b64_tr_b16 v[156:157], v27 offset:18432
    ds_read_b64_tr_b16 v[158:159], v27 offset:19968
    ds_read_b64_tr_b16 v[160:161], v28 offset:18432
    ds_read_b64_tr_b16 v[162:163], v28 offset:19968
    ds_read_b64_tr_b16 v[164:165], v29 offset:18432
    ds_read_b64_tr_b16 v[166:167], v29 offset:19968
    s_waitcnt lgkmcnt(8)
    v_mfma_f32_32x32x16_bf16 v[32:47], v[144:147], v[128:131], v[32:47]
    v_mfma_f32_32x32x16_bf16 v[48:63], v[148:151], v[128:131], v[48:63]
    v_mfma_f32_32x32x16_bf16 v[64:79], v[128:131], v[152:155], v[64:79]
    v_mfma_f32_32x32x16_bf16 v[80:95], v[144:147], v[132:135], v[80:95]
    v_mfma_f32_32x32x16_bf16 v[96:111], v[148:151], v[132:135], v[96:111]
    v_mfma_f32_32x32x16_bf16 v[112:127], v[132:135], v[152:155], v[112:127]
    s_waitcnt lgkmcnt(0)
    v_mfma_f32_32x32x16_bf16 v[32:47], v[156:159], v[136:139], v[32:47]
    v_mfma_f32_32x32x16_bf16 v[48:63], v[160:163], v[136:139], v[48:63]
    v_mfma_f32_32x32x16_bf16 v[64:79], v[136:139], v[164:167], v[64:79]
    v_mfma_f32_32x32x16_bf16 v[80:95], v[156:159], v[140:143], v[80:95]
    v_mfma_f32_32x32x16_bf16 v[96:111], v[160:163], v[140:143], v[96:111]
    v_mfma_f32_32x32x16_bf16 v[112:127], v[140:143], v[164:167], v[112:127]
    s_waitcnt vmcnt(0)
    s_barrier
    ds_read_b128 v[128:131], v16 offset:0
    ds_read_b128 v[132:135], v16 offset:4096
    ds_read_b64_tr_b16 v[144:145], v24 offset:0
    ds_read_b64_tr_b16 v[146:147], v24 offset:1536
    ds_read_b64_tr_b16 v[148:149], v25 offset:0
    ds_read_b64_tr_b16 v[150:151], v25 offset:1536
    ds_read_b64_tr_b16 v[152:153], v26 offset:0
    ds_read_b64_tr_b16 v[154:155], v26 offset:1536
    ds_read_b128 v[136:139], v17 offset:0
    ds_read_b128 v[140:143], v17 offset:4096
    ds_read_b64_tr_b16 v[156:157], v24 offset:6144
    ds_read_b64_tr_b16 v[158:159], v24 offset:7680
    ds_read_b64_tr_b16 v[160:161], v25 offset:6144
    ds_read_b64_tr_b16 v[162:163], v25 offset:7680
    ds_read_b64_tr_b16 v[164:165], v26 offset:6144
    ds_read_b64_tr_b16 v[166:167], v26 offset:7680
    s_waitcnt lgkmcnt(8)
    v_mfma_f32_32x32x16_bf16 v[32:47], v[144:147], v[128:131], v[32:47]
    v_mfma_f32_32x32x16_bf16 v[48:63], v[148:151], v[128:131], v[48:63]
    v_mfma_f32_32x32x16_bf16 v[64:79], v[128:131], v[152:155], v[64:79]
    v_mfma_f32_32x32x16_bf16 v[80:95], v[144:147], v[132:135], v[80:95]
    v_mfma_f32_32x32x16_bf16 v[96:111], v[148:151], v[132:135], v[96:111]
    v_mfma_f32_32x32x16_bf16 v[112:127], v[132:135], v[152:155], v[112:127]
    ds_read_b128 v[128:131], v18 offset:0
    ds_read_b128 v[132:135], v18 offset:4096
    ds_read_b64_tr_b16 v[144:145], v24 offset:12288
    ds_read_b64_tr_b16 v[146:147], v24 offset:13824
    ds_read_b64_tr_b16 v[148:149], v25 offset:12288
    ds_read_b64_tr_b16 v[150:151], v25 offset:13824
    ds_read_b64_tr_b16 v[152:153], v26 offset:12288
    ds_read_b64_tr_b16 v[154:155], v26 offset:13824
    s_waitcnt lgkmcnt(8)
    v_mfma_f32_32x32x16_bf16 v[32:47], v[156:159], v[136:139], v[32:47]
    v_mfma_f32_32x32x16_bf16 v[48:63], v[160:163], v[136:139], v[48:63]
    v_mfma_f32_32x32x16_bf16 v[64:79], v[136:139], v[164:167], v[64:79]
    v_mfma_f32_32x32x16_bf16 v[80:95], v[156:159], v[140:143], v[80:95]
    v_mfma_f32_32x32x16_bf16 v[96:111], v[160:163], v[140:143], v[96:111]
    v_mfma_f32_32x32x16_bf16 v[112:127], v[140:143], v[164:167], v[112:127]
    ds_read_b128 v[136:139], v19 offset:0
    ds_read_b128 v[140:143], v19 offset:4096
    ds_read_b64_tr_b16 v[156:157], v24 offset:18432
    ds_read_b64_tr_b16 v[158:159], v24 offset:19968
    ds_read_b64_tr_b16 v[160:161], v25 offset:18432
    ds_read_b64_tr_b16 v[162:163], v25 offset:19968
    ds_read_b64_tr_b16 v[164:165], v26 offset:18432
    ds_read_b64_tr_b16 v[166:167], v26 offset:19968
    s_waitcnt lgkmcnt(8)
    v_mfma_f32_32x32x16_bf16 v[32:47], v[144:147], v[128:131], v[32:47]
    v_mfma_f32_32x32x16_bf16 v[48:63], v[148:151], v[128:131], v[48:63]
    v_mfma_f32_32x32x16_bf16 v[64:79], v[128:131], v[152:155], v[64:79]
    v_mfma_f32_32x32x16_bf16 v[80:95], v[144:147], v[132:135], v[80:95]
    v_mfma_f32_32x32x16_bf16 v[96:111], v[148:151], v[132:135], v[96:111]
    v_mfma_f32_32x32x16_bf16 v[112:127], v[132:135], v[152:155], v[112:127]
    s_waitcnt lgkmcnt(0)
    v_mfma_f32_32x32x16_bf16 v[32:47], v[156:159], v[136:139], v[32:47]
    v_mfma_f32_32x32x16_bf16 v[48:63], v[160:163], v[136:139], v[48:63]
    v_mfma_f32_32x32x16_bf16 v[64:79], v[136:139], v[164:167], v[64:79]
    v_mfma_f32_32x32x16_bf16 v[80:95], v[156:159], v[140:143], v[80:95]
    v_mfma_f32_32x32x16_bf16 v[96:111], v[160:163], v[140:143], v[96:111]
    v_mfma_f32_32x32x16_bf16 v[112:127], v[140:143], v[164:167], v[112:127]
    s_lshl_b32 s24, s21, 1
    s_add_u32 s24, s24, s23
    s_lshl_b32 s24, s24, 6
    s_lshl_b32 s25, s20, 2
    s_add_u32 s24, s24, s25
    s_lshl_b32 s25, s22, 1
    s_add_u32 s24, s24, s25
    s_lshl_b32 s24, s24, 11
    v_lshlrev_b32 v4, 4, v2
    v_add_u32 v4, s24, v4
    s_mov_b32 s30, 0
    s_mov_b32 s31, -1
    v_and_b32 v5, 31, v2
    v_cmp_le_u32 s[32:33], 28, v5
    v_cmp_eq_u32 vcc, 28, v5
    v_mov_b32 v6, 0x3f803f80
    v_mov_b32 v8, 0
    v_cndmask_b32 v7, v8, v6, vcc
    s_mov_b32 s34, 1049335798
    s_nop 7
    v_mul_f32 v32, s34, v32
    v_mul_f32 v33, s34, v33
    v_mul_f32 v34, s34, v34
    v_mul_f32 v35, s34, v35
    v_mul_f32 v36, s34, v36
    v_mul_f32 v37, s34, v37
    v_mul_f32 v38, s34, v38
    v_mul_f32 v39, s34, v39
    v_mul_f32 v40, s34, v40
    v_mul_f32 v41, s34, v41
    v_mul_f32 v42, s34, v42
    v_mul_f32 v43, s34, v43
    v_mul_f32 v44, s34, v44
    v_mul_f32 v45, s34, v45
    v_mul_f32 v46, s34, v46
    v_mul_f32 v47, s34, v47
    v_cvt_pk_bf16_f32 v128, v32, v33
    v_cvt_pk_bf16_f32 v129, v34, v35
    v_cvt_pk_bf16_f32 v130, v36, v37
    v_cvt_pk_bf16_f32 v131, v38, v39
    v_cvt_pk_bf16_f32 v132, v40, v41
    v_cvt_pk_bf16_f32 v133, v42, v43
    v_cvt_pk_bf16_f32 v134, v44, v45
    v_cvt_pk_bf16_f32 v135, v46, v47
    v_cndmask_b32 v134, v134, v8, s[30:31]
    v_cndmask_b32 v135, v135, v8, s[30:31]
    s_mov_b32 s29, 0
    buffer_store_dwordx4 v[128:131], v4, s[12:15], s29 offen sc0 sc1
    buffer_store_dwordx4 v[132:135], v4, s[12:15], s29 offen offset:1024 sc0 sc1
    s_nop 1
    v_cvt_pk_bf16_f32 v136, v48, v49
    v_cvt_pk_bf16_f32 v137, v50, v51
    v_cvt_pk_bf16_f32 v138, v52, v53
    v_cvt_pk_bf16_f32 v139, v54, v55
    v_cvt_pk_bf16_f32 v140, v56, v57
    v_cvt_pk_bf16_f32 v141, v58, v59
    v_cvt_pk_bf16_f32 v142, v60, v61
    v_cvt_pk_bf16_f32 v143, v62, v63
    v_cndmask_b32 v142, v142, v6, s[30:31]
    v_cndmask_b32 v143, v143, v8, s[30:31]
    s_mov_b32 s29, 2097152
    buffer_store_dwordx4 v[136:139], v4, s[12:15], s29 offen sc0 sc1
    buffer_store_dwordx4 v[140:143], v4, s[12:15], s29 offen offset:1024 sc0 sc1
    s_nop 1
    v_cvt_pk_bf16_f32 v128, v64, v65
    v_cvt_pk_bf16_f32 v129, v66, v67
    v_cvt_pk_bf16_f32 v130, v68, v69
    v_cvt_pk_bf16_f32 v131, v70, v71
    v_cvt_pk_bf16_f32 v132, v72, v73
    v_cvt_pk_bf16_f32 v133, v74, v75
    v_cvt_pk_bf16_f32 v134, v76, v77
    v_cvt_pk_bf16_f32 v135, v78, v79
    v_cndmask_b32 v128, v128, v7, s[32:33]
    v_cndmask_b32 v129, v129, v7, s[32:33]
    v_cndmask_b32 v130, v130, v7, s[32:33]
    v_cndmask_b32 v131, v131, v7, s[32:33]
    v_cndmask_b32 v132, v132, v7, s[32:33]
    v_cndmask_b32 v133, v133, v7, s[32:33]
    v_cndmask_b32 v134, v134, v7, s[32:33]
    v_cndmask_b32 v135, v135, v7, s[32:33]
    s_mov_b32 s29, 4194304
    buffer_store_dwordx4 v[128:131], v4, s[12:15], s29 offen sc0 sc1
    buffer_store_dwordx4 v[132:135], v4, s[12:15], s29 offen offset:1024 sc0 sc1
    s_nop 1
    v_mul_f32 v80, s34, v80
    v_mul_f32 v81, s34, v81
    v_mul_f32 v82, s34, v82
    v_mul_f32 v83, s34, v83
    v_mul_f32 v84, s34, v84
    v_mul_f32 v85, s34, v85
    v_mul_f32 v86, s34, v86
    v_mul_f32 v87, s34, v87
    v_mul_f32 v88, s34, v88
    v_mul_f32 v89, s34, v89
    v_mul_f32 v90, s34, v90
    v_mul_f32 v91, s34, v91
    v_mul_f32 v92, s34, v92
    v_mul_f32 v93, s34, v93
    v_mul_f32 v94, s34, v94
    v_mul_f32 v95, s34, v95
    v_cvt_pk_bf16_f32 v136, v80, v81
    v_cvt_pk_bf16_f32 v137, v82, v83
    v_cvt_pk_bf16_f32 v138, v84, v85
    v_cvt_pk_bf16_f32 v139, v86, v87
    v_cvt_pk_bf16_f32 v140, v88, v89
    v_cvt_pk_bf16_f32 v141, v90, v91
    v_cvt_pk_bf16_f32 v142, v92, v93
    v_cvt_pk_bf16_f32 v143, v94, v95
    v_cndmask_b32 v142, v142, v8, s[30:31]
    v_cndmask_b32 v143, v143, v8, s[30:31]
    s_mov_b32 s29, 2048
    buffer_store_dwordx4 v[136:139], v4, s[12:15], s29 offen sc0 sc1
    buffer_store_dwordx4 v[140:143], v4, s[12:15], s29 offen offset:1024 sc0 sc1
    s_nop 1
    v_cvt_pk_bf16_f32 v128, v96, v97
    v_cvt_pk_bf16_f32 v129, v98, v99
    v_cvt_pk_bf16_f32 v130, v100, v101
    v_cvt_pk_bf16_f32 v131, v102, v103
    v_cvt_pk_bf16_f32 v132, v104, v105
    v_cvt_pk_bf16_f32 v133, v106, v107
    v_cvt_pk_bf16_f32 v134, v108, v109
    v_cvt_pk_bf16_f32 v135, v110, v111
    v_cndmask_b32 v134, v134, v6, s[30:31]
    v_cndmask_b32 v135, v135, v8, s[30:31]
    s_mov_b32 s29, 2099200
    buffer_store_dwordx4 v[128:131], v4, s[12:15], s29 offen sc0 sc1
    buffer_store_dwordx4 v[132:135], v4, s[12:15], s29 offen offset:1024 sc0 sc1
    s_nop 1
    v_cvt_pk_bf16_f32 v136, v112, v113
    v_cvt_pk_bf16_f32 v137, v114, v115
    v_cvt_pk_bf16_f32 v138, v116, v117
    v_cvt_pk_bf16_f32 v139, v118, v119
    v_cvt_pk_bf16_f32 v140, v120, v121
    v_cvt_pk_bf16_f32 v141, v122, v123
    v_cvt_pk_bf16_f32 v142, v124, v125
    v_cvt_pk_bf16_f32 v143, v126, v127
    v_cndmask_b32 v136, v136, v7, s[32:33]
    v_cndmask_b32 v137, v137, v7, s[32:33]
    v_cndmask_b32 v138, v138, v7, s[32:33]
    v_cndmask_b32 v139, v139, v7, s[32:33]
    v_cndmask_b32 v140, v140, v7, s[32:33]
    v_cndmask_b32 v141, v141, v7, s[32:33]
    v_cndmask_b32 v142, v142, v7, s[32:33]
    v_cndmask_b32 v143, v143, v7, s[32:33]
    s_mov_b32 s29, 4196352
    buffer_store_dwordx4 v[136:139], v4, s[12:15], s29 offen sc0 sc1
    buffer_store_dwordx4 v[140:143], v4, s[12:15], s29 offen offset:1024 sc0 sc1
    s_nop 1
    s_endpgm
K1_A:
    s_load_dwordx2 s[36:37], s[0:1], 0
    s_load_dwordx4 s[44:47], s[0:1], 24
    s_load_dwordx4 s[48:51], s[0:1], 8
    s_load_dwordx2 s[52:53], s[0:1], 56
    s_cmp_ge_u32 s18, 28
    s_cbranch_scc1 K1_END
    s_and_b32 s22, s3, 1
    s_lshr_b32 s23, s3, 1
    s_lshl_b32 s24, s20, 7
    s_lshl_b32 s25, s23, 6
    s_add_u32 s24, s24, s25
    s_lshl_b32 s25, s22, 4
    s_add_u32 s24, s24, s25
    v_lshrrev_b32 v6, 5, v2
    v_lshlrev_b32 v6, 5, v6
    v_bfe_u32 v7, v2, 3, 2
    v_add3_u32 v6, v6, v7, s24
    v_mul_u32_u24 v6, 896, v6
    v_and_b32 v7, 7, v2
    v_lshrrev_b32 v8, 4, v2
    v_xor_b32 v7, v7, v8
    v_xor_b32 v9, 4, v7
    v_lshl_add_u32 v4, v7, 4, v6
    v_lshl_add_u32 v5, v9, 4, v6
    s_lshl_b32 s24, s21, 1
    s_add_u32 s24, s24, s23
    s_lshl_b32 s24, s24, 5
    v_lshrrev_b32 v6, 3, v2
    v_add_u32 v6, s24, v6
    v_mul_u32_u24 v6, 896, v6
    v_lshl_add_u32 v10, v7, 4, v6
    v_lshl_add_u32 v11, v9, 4, v6
    v_and_b32 v6, 31, v2
    v_lshrrev_b32 v7, 5, v2
    v_bfe_u32 v19, v6, 1, 3
    v_xor_b32 v7, v7, v19
    v_lshlrev_b32 v6, 7, v6
    v_xor_b32 v16, 0, v7
    v_lshl_add_u32 v16, v16, 4, v6
    v_xor_b32 v17, 2, v7
    v_lshl_add_u32 v17, v17, 4, v6
    v_xor_b32 v18, 4, v7
    v_lshl_add_u32 v18, v18, 4, v6
    v_xor_b32 v19, 6, v7
    v_lshl_add_u32 v19, v19, 4, v6
    s_lshl_b32 s24, s22, 13
    s_lshl_b32 s25, s23, 13
    s_add_u32 s25, s25, 16384
    v_add_u32 v24, s25, v16
    v_add_u32 v28, 81920, v24
    v_add_u32 v16, s24, v16
    v_add_u32 v20, 81920, v16
    v_add_u32 v25, s25, v17
    v_add_u32 v29, 81920, v25
    v_add_u32 v17, s24, v17
    v_add_u32 v21, 81920, v17
    v_add_u32 v26, s25, v18
    v_add_u32 v30, 81920, v26
    v_add_u32 v18, s24, v18
    v_add_u32 v22, 81920, v18
    v_add_u32 v27, s25, v19
    v_add_u32 v31, 81920, v27
    v_add_u32 v19, s24, v19
    v_add_u32 v23, 81920, v19
    s_waitcnt lgkmcnt(0)
    s_mov_b32 s4, s36
    s_and_b32 s5, s37, 0xffff
    s_mov_b32 s6, 1835008
    s_mov_b32 s7, 0x00020000
    s_cmp_eq_u32 s22, 0
    s_cselect_b32 s38, s44, s46
    s_cselect_b32 s39, s45, s47
    s_mov_b32 s8, s38
    s_and_b32 s9, s39, 0xffff
    s_mov_b32 s10, 401408
    s_mov_b32 s11, 0x00020000
    s_mov_b32 s12, s40
    s_and_b32 s13, s41, 0xffff
    s_mov_b32 s14, 13893632
    s_mov_b32 s15, 0x00020000
    s_mov_b32 s56, s48
    s_and_b32 s57, s49, 0xffff
    s_mov_b32 s58, 896
    s_mov_b32 s59, 0x00020000
    s_mov_b32 s60, s50
    s_and_b32 s61, s51, 0xffff
    s_mov_b32 s62, 896
    s_mov_b32 s63, 0x00020000
    s_mov_b32 s64, s52
    s_and_b32 s65, s53, 0xffff
    s_mov_b32 s66, 896
    s_mov_b32 s67, 0x00020000
    s_lshl_b32 s24, s21, 1
    s_add_u32 s24, s24, s23
    s_lshl_b32 s25, s24, 6
    v_and_b32 v128, 31, v2
    v_lshlrev_b32 v128, 1, v128
    v_add_u32 v128, s25, v128
    buffer_load_ushort v130, v128, s[56:59], 0 offen
    buffer_load_ushort v131, v128, s[60:63], 0 offen
    buffer_load_ushort v132, v128, s[64:67], 0 offen
    s_lshl_b32 s27, s3, 12
    s_add_u32 m0, s27, 16384
    s_mov_b32 s29, 0
    buffer_load_dwordx4 v10, s[8:11], s29 offen lds
    s_add_u32 m0, s27, 17408
    s_mov_b32 s29, 7168
    buffer_load_dwordx4 v11, s[8:11], s29 offen lds
    s_add_u32 m0, s27, 18432
    s_mov_b32 s29, 14336
    buffer_load_dwordx4 v10, s[8:11], s29 offen lds
    s_add_u32 m0, s27, 19456
    s_mov_b32 s29, 21504
    buffer_load_dwordx4 v11, s[8:11], s29 offen lds
    s_add_u32 m0, s27, 0
    s_mov_b32 s29, 0
    buffer_load_dwordx4 v4, s[4:7], s29 offen lds
    s_add_u32 m0, s27, 1024
    s_mov_b32 s29, 3584
    buffer_load_dwordx4 v5, s[4:7], s29 offen lds
    s_add_u32 m0, s27, 2048
    s_mov_b32 s29, 7168
    buffer_load_dwordx4 v4, s[4:7], s29 offen lds
    s_add_u32 m0, s27, 3072
    s_mov_b32 s29, 10752
    buffer_load_dwordx4 v5, s[4:7], s29 offen lds
    s_add_u32 m0, s27, 57344
    s_mov_b32 s29, 128
    buffer_load_dwordx4 v10, s[8:11], s29 offen lds
    s_add_u32 m0, s27, 58368
    s_mov_b32 s29, 7296
    buffer_load_dwordx4 v11, s[8:11], s29 offen lds
    s_add_u32 m0, s27, 59392
    s_mov_b32 s29, 14464
    buffer_load_dwordx4 v10, s[8:11], s29 offen lds
    s_add_u32 m0, s27, 60416
    s_mov_b32 s29, 21632
    buffer_load_dwordx4 v11, s[8:11], s29 offen lds
    s_add_u32 m0, s27, 40960
    s_mov_b32 s29, 128
    buffer_load_dwordx4 v4, s[4:7], s29 offen lds
    s_add_u32 m0, s27, 41984
    s_mov_b32 s29, 3712
    buffer_load_dwordx4 v5, s[4:7], s29 offen lds
    s_add_u32 m0, s27, 43008
    s_mov_b32 s29, 7296
    buffer_load_dwordx4 v4, s[4:7], s29 offen lds
    s_add_u32 m0, s27, 44032
    s_mov_b32 s29, 10880
    buffer_load_dwordx4 v5, s[4:7], s29 offen lds
    s_cmp_lt_u32 s16, 35
    s_cselect_b32 s38, s44, s46
    s_cselect_b32 s39, s45, s47
    s_cselect_b32 s25, 0, 35
    s_sub_u32 s25, s16, s25
    s_mov_b32 s48, s38
    s_and_b32 s49, s39, 0xffff
    s_mov_b32 s50, 401408
    s_mov_b32 s51, 0x00020000
    s_mul_i32 s26, s25, 37
    s_lshr_b32 s26, s26, 8
    s_mul_i32 s24, s26, 7
    s_sub_u32 s24, s25, s24
    s_mul_i32 s24, s24, 57344
    s_lshl_b32 s26, s26, 7
    s_add_u32 s24, s24, s26
    s_add_u32 s24, s24, 256
    s_cmp_lt_u32 s16, 70
    s_cselect_b32 s24, s24, 0x7ff00000
    v_mul_u32_u24 v6, 896, v2
    v_add_u32 v7, s24, v6
    buffer_load_dword v142, v7, s[48:51], 0 offen
    s_sub_u32 s25, s16, 70
    s_and_b32 s24, s25, 7
    s_lshl_b32 s26, s17, 3
    s_add_u32 s24, s24, s26
    s_mul_i32 s24, s24, 57344
    s_lshr_b32 s26, s25, 3
    s_lshl_b32 s26, s26, 7
    s_add_u32 s24, s24, s26
    s_add_u32 s24, s24, 256
    s_cmp_lt_u32 s25, 40
    s_cselect_b32 s24, s24, 0x7ff00000
    v_add_u32 v7, s24, v6
    buffer_load_dword v143, v7, s[4:7], 0 offen
    v_mov_b32 v32, 0
    v_mov_b32 v33, 0
    v_mov_b32 v34, 0
    v_mov_b32 v35, 0
    v_mov_b32 v36, 0
    v_mov_b32 v37, 0
    v_mov_b32 v38, 0
    v_mov_b32 v39, 0
    v_mov_b32 v40, 0
    v_mov_b32 v41, 0
    v_mov_b32 v42, 0
    v_mov_b32 v43, 0
    v_mov_b32 v44, 0
    v_mov_b32 v45, 0
    v_mov_b32 v46, 0
    v_mov_b32 v47, 0
    v_mov_b32 v48, 0
    v_mov_b32 v49, 0
    v_mov_b32 v50, 0
    v_mov_b32 v51, 0
    v_mov_b32 v52, 0
    v_mov_b32 v53, 0
    v_mov_b32 v54, 0
    v_mov_b32 v55, 0
    v_mov_b32 v56, 0
    v_mov_b32 v57, 0
    v_mov_b32 v58, 0
    v_mov_b32 v59, 0
    v_mov_b32 v60, 0
    v_mov_b32 v61, 0
    v_mov_b32 v62, 0
    v_mov_b32 v63, 0
    v_mov_b32 v64, 0
    v_mov_b32 v65, 0
    v_mov_b32 v66, 0
    v_mov_b32 v67, 0
    v_mov_b32 v68, 0
    v_mov_b32 v69, 0
    v_mov_b32 v70, 0
    v_mov_b32 v71, 0
    v_mov_b32 v72, 0
    v_mov_b32 v73, 0
    v_mov_b32 v74, 0
    v_mov_b32 v75, 0
    v_mov_b32 v76, 0
    v_mov_b32 v77, 0
    v_mov_b32 v78, 0
    v_mov_b32 v79, 0
    v_mov_b32 v80, 0
    v_mov_b32 v81, 0
    v_mov_b32 v82, 0
    v_mov_b32 v83, 0
    v_mov_b32 v84, 0
    v_mov_b32 v85, 0
    v_mov_b32 v86, 0
    v_mov_b32 v87, 0
    v_mov_b32 v88, 0
    v_mov_b32 v89, 0
    v_mov_b32 v90, 0
    v_mov_b32 v91, 0
    v_mov_b32 v92, 0
    v_mov_b32 v93, 0
    v_mov_b32 v94, 0
    v_mov_b32 v95, 0
    s_waitcnt vmcnt(18)
    v_lshlrev_b32 v130, 16, v130
    v_lshlrev_b32 v131, 16, v131
    v_lshlrev_b32 v132, 16, v132
    v_mul_f32 v132, 0x3fb8aa3b, v132
    v_exp_f32 v132, v132
    s_nop 1
    v_cvt_pk_bf16_f32 v132, v132, v132
    v_and_b32 v132, 0xffff0000, v132
    v_mul_f32 v133, v132, v130
    v_mul_f32 v134, v132, v131
    v_mul_f32 v133, 0x3fb8aa3b, v133
    v_exp_f32 v133, v133
    v_mul_f32 v134, 0.15915494, v134
    v_fract_f32 v134, v134
    v_sin_f32 v135, v134
    v_cos_f32 v136, v134
    s_nop 1
    v_mul_f32 v138, v133, v136
    v_mul_f32 v139, v133, v135
    v_add_f32 v133, -1.0, v138
    v_mul_f32 v134, v130, v130
    v_fmac_f32 v134, v131, v131
    v_rcp_f32 v134, v134
    v_mul_f32 v135, v133, v130
    v_fmac_f32 v135, v139, v131
    v_mul_f32 v136, v139, v130
    v_fma_f32 v136, -v133, v131, v136
    v_mul_f32 v140, v135, v134
    v_mul_f32 v141, v136, v134
    s_waitcnt vmcnt(10)
    s_barrier
    ds_read_b128 v[96:99], v16 offset:0
    ds_read_b128 v[100:103], v16 offset:4096
    ds_read_b128 v[112:115], v24 offset:0
    ds_read_b128 v[116:119], v24 offset:4096
    ds_read_b128 v[104:107], v17 offset:0
    ds_read_b128 v[108:111], v17 offset:4096
    ds_read_b128 v[120:123], v25 offset:0
    ds_read_b128 v[124:127], v25 offset:4096
    s_waitcnt lgkmcnt(4)
    v_mfma_f32_32x32x16_bf16 v[32:47], v[96:99], v[112:115], v[32:47]
    s_add_u32 m0, s27, 98304
    s_mov_b32 s29, 256
    buffer_load_dwordx4 v10, s[8:11], s29 offen lds
    v_mfma_f32_32x32x16_bf16 v[48:63], v[96:99], v[116:119], v[48:63]
    s_add_u32 m0, s27, 99328
    s_mov_b32 s29, 7424
    buffer_load_dwordx4 v11, s[8:11], s29 offen lds
    v_mfma_f32_32x32x16_bf16 v[64:79], v[100:103], v[112:115], v[64:79]
    v_mfma_f32_32x32x16_bf16 v[80:95], v[100:103], v[116:119], v[80:95]
    ds_read_b128 v[96:99], v18 offset:0
    ds_read_b128 v[100:103], v18 offset:4096
    ds_read_b128 v[112:115], v26 offset:0
    ds_read_b128 v[116:119], v26 offset:4096
    s_waitcnt lgkmcnt(4)
    v_mfma_f32_32x32x16_bf16 v[32:47], v[104:107], v[120:123], v[32:47]
    s_add_u32 m0, s27, 100352
    s_mov_b32 s29, 14592
    buffer_load_dwordx4 v10, s[8:11], s29 offen lds
    v_mfma_f32_32x32x16_bf16 v[48:63], v[104:107], v[124:127], v[48:63]
    s_add_u32 m0, s27, 101376
    s_mov_b32 s29, 21760
    buffer_load_dwordx4 v11, s[8:11], s29 offen lds
    v_mfma_f32_32x32x16_bf16 v[64:79], v[108:111], v[120:123], v[64:79]
    v_mfma_f32_32x32x16_bf16 v[80:95], v[108:111], v[124:127], v[80:95]
    ds_read_b128 v[104:107], v19 offset:0
    ds_read_b128 v[108:111], v19 offset:4096
    ds_read_b128 v[120:123], v27 offset:0
    ds_read_b128 v[124:127], v27 offset:4096
    s_waitcnt lgkmcnt(4)
    v_mfma_f32_32x32x16_bf16 v[32:47], v[96:99], v[112:115], v[32:47]
    s_add_u32 m0, s27, 81920
    s_mov_b32 s29, 256
    buffer_load_dwordx4 v4, s[4:7], s29 offen lds
    v_mfma_f32_32x32x16_bf16 v[48:63], v[96:99], v[116:119], v[48:63]
    s_add_u32 m0, s27, 82944
    s_mov_b32 s29, 3840
    buffer_load_dwordx4 v5, s[4:7], s29 offen lds
    v_mfma_f32_32x32x16_bf16 v[64:79], v[100:103], v[112:115], v[64:79]
    v_mfma_f32_32x32x16_bf16 v[80:95], v[100:103], v[116:119], v[80:95]
    s_waitcnt lgkmcnt(0)
    v_mfma_f32_32x32x16_bf16 v[32:47], v[104:107], v[120:123], v[32:47]
    s_add_u32 m0, s27, 83968
    s_mov_b32 s29, 7424
    buffer_load_dwordx4 v4, s[4:7], s29 offen lds
    v_mfma_f32_32x32x16_bf16 v[48:63], v[104:107], v[124:127], v[48:63]
    s_add_u32 m0, s27, 84992
    s_mov_b32 s29, 11008
    buffer_load_dwordx4 v5, s[4:7], s29 offen lds
    v_mfma_f32_32x32x16_bf16 v[64:79], v[108:111], v[120:123], v[64:79]
    v_mfma_f32_32x32x16_bf16 v[80:95], v[108:111], v[124:127], v[80:95]
    s_waitcnt vmcnt(10)
    s_barrier
    ds_read_b128 v[96:99], v16 offset:40960
    ds_read_b128 v[100:103], v16 offset:45056
    ds_read_b128 v[112:115], v24 offset:40960
    ds_read_b128 v[116:119], v24 offset:45056
    ds_read_b128 v[104:107], v17 offset:40960
    ds_read_b128 v[108:111], v17 offset:45056
    ds_read_b128 v[120:123], v25 offset:40960
    ds_read_b128 v[124:127], v25 offset:45056
    s_waitcnt lgkmcnt(4)
    v_mfma_f32_32x32x16_bf16 v[32:47], v[96:99], v[112:115], v[32:47]
    s_add_u32 m0, s27, 16384
    s_mov_b32 s29, 384
    buffer_load_dwordx4 v10, s[8:11], s29 offen lds
    v_mfma_f32_32x32x16_bf16 v[48:63], v[96:99], v[116:119], v[48:63]
    s_add_u32 m0, s27, 17408
    s_mov_b32 s29, 7552
    buffer_load_dwordx4 v11, s[8:11], s29 offen lds
    v_mfma_f32_32x32x16_bf16 v[64:79], v[100:103], v[112:115], v[64:79]
    v_mfma_f32_32x32x16_bf16 v[80:95], v[100:103], v[116:119], v[80:95]
    ds_read_b128 v[96:99], v18 offset:40960
    ds_read_b128 v[100:103], v18 offset:45056
    ds_read_b128 v[112:115], v26 offset:40960
    ds_read_b128 v[116:119], v26 offset:45056
    s_waitcnt lgkmcnt(4)
    v_mfma_f32_32x32x16_bf16 v[32:47], v[104:107], v[120:123], v[32:47]
    s_add_u32 m0, s27, 18432
    s_mov_b32 s29, 14720
    buffer_load_dwordx4 v10, s[8:11], s29 offen lds
    v_mfma_f32_32x32x16_bf16 v[48:63], v[104:107], v[124:127], v[48:63]
    s_add_u32 m0, s27, 19456
    s_mov_b32 s29, 21888
    buffer_load_dwordx4 v11, s[8:11], s29 offen lds
    v_mfma_f32_32x32x16_bf16 v[64:79], v[108:111], v[120:123], v[64:79]
    v_mfma_f32_32x32x16_bf16 v[80:95], v[108:111], v[124:127], v[80:95]
    ds_read_b128 v[104:107], v19 offset:40960
    ds_read_b128 v[108:111], v19 offset:45056
    ds_read_b128 v[120:123], v27 offset:40960
    ds_read_b128 v[124:127], v27 offset:45056
    s_waitcnt lgkmcnt(4)
    v_mfma_f32_32x32x16_bf16 v[32:47], v[96:99], v[112:115], v[32:47]
    s_add_u32 m0, s27, 0
    s_mov_b32 s29, 384
    buffer_load_dwordx4 v4, s[4:7], s29 offen lds
    v_mfma_f32_32x32x16_bf16 v[48:63], v[96:99], v[116:119], v[48:63]
    s_add_u32 m0, s27, 1024
    s_mov_b32 s29, 3968
    buffer_load_dwordx4 v5, s[4:7], s29 offen lds
    v_mfma_f32_32x32x16_bf16 v[64:79], v[100:103], v[112:115], v[64:79]
    v_mfma_f32_32x32x16_bf16 v[80:95], v[100:103], v[116:119], v[80:95]
    s_waitcnt lgkmcnt(0)
    v_mfma_f32_32x32x16_bf16 v[32:47], v[104:107], v[120:123], v[32:47]
    s_add_u32 m0, s27, 2048
    s_mov_b32 s29, 7552
    buffer_load_dwordx4 v4, s[4:7], s29 offen lds
    v_mfma_f32_32x32x16_bf16 v[48:63], v[104:107], v[124:127], v[48:63]
    s_add_u32 m0, s27, 3072
    s_mov_b32 s29, 11136
    buffer_load_dwordx4 v5, s[4:7], s29 offen lds
    v_mfma_f32_32x32x16_bf16 v[64:79], v[108:111], v[120:123], v[64:79]
    v_mfma_f32_32x32x16_bf16 v[80:95], v[108:111], v[124:127], v[80:95]
    s_waitcnt vmcnt(8)
    s_barrier
    ds_read_b128 v[96:99], v20 offset:0
    ds_read_b128 v[100:103], v20 offset:4096
    ds_read_b128 v[112:115], v28 offset:0
    ds_read_b128 v[116:119], v28 offset:4096
    ds_read_b128 v[104:107], v21 offset:0
    ds_read_b128 v[108:111], v21 offset:4096
    ds_read_b128 v[120:123], v29 offset:0
    ds_read_b128 v[124:127], v29 offset:4096
    s_waitcnt lgkmcnt(4)
    v_mfma_f32_32x32x16_bf16 v[32:47], v[96:99], v[112:115], v[32:47]
    s_add_u32 m0, s27, 57344
    s_mov_b32 s29, 512
    buffer_load_dwordx4 v10, s[8:11], s29 offen lds
    v_mfma_f32_32x32x16_bf16 v[48:63], v[96:99], v[116:119], v[48:63]
    s_add_u32 m0, s27, 58368
    s_mov_b32 s29, 7680
    buffer_load_dwordx4 v11, s[8:11], s29 offen lds
    v_mfma_f32_32x32x16_bf16 v[64:79], v[100:103], v[112:115], v[64:79]
    v_mfma_f32_32x32x16_bf16 v[80:95], v[100:103], v[116:119], v[80:95]
    ds_read_b128 v[96:99], v22 offset:0
    ds_read_b128 v[100:103], v22 offset:4096
    ds_read_b128 v[112:115], v30 offset:0
    ds_read_b128 v[116:119], v30 offset:4096
    s_waitcnt lgkmcnt(4)
    v_mfma_f32_32x32x16_bf16 v[32:47], v[104:107], v[120:123], v[32:47]
    s_add_u32 m0, s27, 59392
    s_mov_b32 s29, 14848
    buffer_load_dwordx4 v10, s[8:11], s29 offen lds
    v_mfma_f32_32x32x16_bf16 v[48:63], v[104:107], v[124:127], v[48:63]
    s_add_u32 m0, s27, 60416
    s_mov_b32 s29, 22016
    buffer_load_dwordx4 v11, s[8:11], s29 offen lds
    v_mfma_f32_32x32x16_bf16 v[64:79], v[108:111], v[120:123], v[64:79]
    v_mfma_f32_32x32x16_bf16 v[80:95], v[108:111], v[124:127], v[80:95]
    ds_read_b128 v[104:107], v23 offset:0
    ds_read_b128 v[108:111], v23 offset:4096
    ds_read_b128 v[120:123], v31 offset:0
    ds_read_b128 v[124:127], v31 offset:4096
    s_waitcnt lgkmcnt(4)
    v_mfma_f32_32x32x16_bf16 v[32:47], v[96:99], v[112:115], v[32:47]
    s_add_u32 m0, s27, 40960
    s_mov_b32 s29, 512
    buffer_load_dwordx4 v4, s[4:7], s29 offen lds
    v_mfma_f32_32x32x16_bf16 v[48:63], v[96:99], v[116:119], v[48:63]
    s_add_u32 m0, s27, 41984
    s_mov_b32 s29, 4096
    buffer_load_dwordx4 v5, s[4:7], s29 offen lds
    v_mfma_f32_32x32x16_bf16 v[64:79], v[100:103], v[112:115], v[64:79]
    v_mfma_f32_32x32x16_bf16 v[80:95], v[100:103], v[116:119], v[80:95]
    s_waitcnt lgkmcnt(0)
    v_mfma_f32_32x32x16_bf16 v[32:47], v[104:107], v[120:123], v[32:47]
    s_add_u32 m0, s27, 43008
    s_mov_b32 s29, 7680
    buffer_load_dwordx4 v4, s[4:7], s29 offen lds
    v_mfma_f32_32x32x16_bf16 v[48:63], v[104:107], v[124:127], v[48:63]
    s_add_u32 m0, s27, 44032
    s_mov_b32 s29, 11264
    buffer_load_dwordx4 v5, s[4:7], s29 offen lds
    v_mfma_f32_32x32x16_bf16 v[64:79], v[108:111], v[120:123], v[64:79]
    v_mfma_f32_32x32x16_bf16 v[80:95], v[108:111], v[124:127], v[80:95]
    s_waitcnt vmcnt(8)
    s_barrier
    ds_read_b128 v[96:99], v16 offset:0
    ds_read_b128 v[100:103], v16 offset:4096
    ds_read_b128 v[112:115], v24 offset:0
    ds_read_b128 v[116:119], v24 offset:4096
    ds_read_b128 v[104:107], v17 offset:0
    ds_read_b128 v[108:111], v17 offset:4096
    ds_read_b128 v[120:123], v25 offset:0
    ds_read_b128 v[124:127], v25 offset:4096
    s_waitcnt lgkmcnt(4)
    v_mfma_f32_32x32x16_bf16 v[32:47], v[96:99], v[112:115], v[32:47]
    s_add_u32 m0, s27, 98304
    s_mov_b32 s29, 640
    buffer_load_dwordx4 v10, s[8:11], s29 offen lds
    v_mfma_f32_32x32x16_bf16 v[48:63], v[96:99], v[116:119], v[48:63]
    s_add_u32 m0, s27, 99328
    s_mov_b32 s29, 7808
    buffer_load_dwordx4 v11, s[8:11], s29 offen lds
    v_mfma_f32_32x32x16_bf16 v[64:79], v[100:103], v[112:115], v[64:79]
    v_mfma_f32_32x32x16_bf16 v[80:95], v[100:103], v[116:119], v[80:95]
    ds_read_b128 v[96:99], v18 offset:0
    ds_read_b128 v[100:103], v18 offset:4096
    ds_read_b128 v[112:115], v26 offset:0
    ds_read_b128 v[116:119], v26 offset:4096
    s_waitcnt lgkmcnt(4)
    v_mfma_f32_32x32x16_bf16 v[32:47], v[104:107], v[120:123], v[32:47]
    s_add_u32 m0, s27, 100352
    s_mov_b32 s29, 14976
    buffer_load_dwordx4 v10, s[8:11], s29 offen lds
    v_mfma_f32_32x32x16_bf16 v[48:63], v[104:107], v[124:127], v[48:63]
    s_add_u32 m0, s27, 101376
    s_mov_b32 s29, 22144
    buffer_load_dwordx4 v11, s[8:11], s29 offen lds
    v_mfma_f32_32x32x16_bf16 v[64:79], v[108:111], v[120:123], v[64:79]
    v_mfma_f32_32x32x16_bf16 v[80:95], v[108:111], v[124:127], v[80:95]
    ds_read_b128 v[104:107], v19 offset:0
    ds_read_b128 v[108:111], v19 offset:4096
    ds_read_b128 v[120:123], v27 offset:0
    ds_read_b128 v[124:127], v27 offset:4096
    s_waitcnt lgkmcnt(4)
    v_mfma_f32_32x32x16_bf16 v[32:47], v[96:99], v[112:115], v[32:47]
    s_add_u32 m0, s27, 81920
    s_mov_b32 s29, 640
    buffer_load_dwordx4 v4, s[4:7], s29 offen lds
    v_mfma_f32_32x32x16_bf16 v[48:63], v[96:99], v[116:119], v[48:63]
    s_add_u32 m0, s27, 82944
    s_mov_b32 s29, 4224
    buffer_load_dwordx4 v5, s[4:7], s29 offen lds
    v_mfma_f32_32x32x16_bf16 v[64:79], v[100:103], v[112:115], v[64:79]
    v_mfma_f32_32x32x16_bf16 v[80:95], v[100:103], v[116:119], v[80:95]
    s_waitcnt lgkmcnt(0)
    v_mfma_f32_32x32x16_bf16 v[32:47], v[104:107], v[120:123], v[32:47]
    s_add_u32 m0, s27, 83968
    s_mov_b32 s29, 7808
    buffer_load_dwordx4 v4, s[4:7], s29 offen lds
    v_mfma_f32_32x32x16_bf16 v[48:63], v[104:107], v[124:127], v[48:63]
    s_add_u32 m0, s27, 84992
    s_mov_b32 s29, 11392
    buffer_load_dwordx4 v5, s[4:7], s29 offen lds
    v_mfma_f32_32x32x16_bf16 v[64:79], v[108:111], v[120:123], v[64:79]
    v_mfma_f32_32x32x16_bf16 v[80:95], v[108:111], v[124:127], v[80:95]
    s_waitcnt vmcnt(8)
    s_barrier
    ds_read_b128 v[96:99], v16 offset:40960
    ds_read_b128 v[100:103], v16 offset:45056
    ds_read_b128 v[112:115], v24 offset:40960
    ds_read_b128 v[116:119], v24 offset:45056
    ds_read_b128 v[104:107], v17 offset:40960
    ds_read_b128 v[108:111], v17 offset:45056
    ds_read_b128 v[120:123], v25 offset:40960
    ds_read_b128 v[124:127], v25 offset:45056
    s_waitcnt lgkmcnt(4)
    v_mfma_f32_32x32x16_bf16 v[32:47], v[96:99], v[112:115], v[32:47]
    s_add_u32 m0, s27, 16384
    s_mov_b32 s29, 768
    buffer_load_dwordx4 v10, s[8:11], s29 offen lds
    v_mfma_f32_32x32x16_bf16 v[48:63], v[96:99], v[116:119], v[48:63]
    s_add_u32 m0, s27, 17408
    s_mov_b32 s29, 7936
    buffer_load_dwordx4 v11, s[8:11], s29 offen lds
    v_mfma_f32_32x32x16_bf16 v[64:79], v[100:103], v[112:115], v[64:79]
    v_mfma_f32_32x32x16_bf16 v[80:95], v[100:103], v[116:119], v[80:95]
    ds_read_b128 v[96:99], v18 offset:40960
    ds_read_b128 v[100:103], v18 offset:45056
    ds_read_b128 v[112:115], v26 offset:40960
    ds_read_b128 v[116:119], v26 offset:45056
    s_waitcnt lgkmcnt(4)
    v_mfma_f32_32x32x16_bf16 v[32:47], v[104:107], v[120:123], v[32:47]
    s_add_u32 m0, s27, 18432
    s_mov_b32 s29, 15104
    buffer_load_dwordx4 v10, s[8:11], s29 offen lds
    v_mfma_f32_32x32x16_bf16 v[48:63], v[104:107], v[124:127], v[48:63]
    s_add_u32 m0, s27, 19456
    s_mov_b32 s29, 22272
    buffer_load_dwordx4 v11, s[8:11], s29 offen lds
    v_mfma_f32_32x32x16_bf16 v[64:79], v[108:111], v[120:123], v[64:79]
    v_mfma_f32_32x32x16_bf16 v[80:95], v[108:111], v[124:127], v[80:95]
    ds_read_b128 v[104:107], v19 offset:40960
    ds_read_b128 v[108:111], v19 offset:45056
    ds_read_b128 v[120:123], v27 offset:40960
    ds_read_b128 v[124:127], v27 offset:45056
    s_waitcnt lgkmcnt(4)
    v_mfma_f32_32x32x16_bf16 v[32:47], v[96:99], v[112:115], v[32:47]
    s_add_u32 m0, s27, 0
    s_mov_b32 s29, 768
    buffer_load_dwordx4 v4, s[4:7], s29 offen lds
    v_mfma_f32_32x32x16_bf16 v[48:63], v[96:99], v[116:119], v[48:63]
    s_add_u32 m0, s27, 1024
    s_mov_b32 s29, 4352
    buffer_load_dwordx4 v5, s[4:7], s29 offen lds
    v_mfma_f32_32x32x16_bf16 v[64:79], v[100:103], v[112:115], v[64:79]
    v_mfma_f32_32x32x16_bf16 v[80:95], v[100:103], v[116:119], v[80:95]
    s_waitcnt lgkmcnt(0)
    v_mfma_f32_32x32x16_bf16 v[32:47], v[104:107], v[120:123], v[32:47]
    s_add_u32 m0, s27, 2048
    s_mov_b32 s29, 7936
    buffer_load_dwordx4 v4, s[4:7], s29 offen lds
    v_mfma_f32_32x32x16_bf16 v[48:63], v[104:107], v[124:127], v[48:63]
    s_add_u32 m0, s27, 3072
    s_mov_b32 s29, 11520
    buffer_load_dwordx4 v5, s[4:7], s29 offen lds
    v_mfma_f32_32x32x16_bf16 v[64:79], v[108:111], v[120:123], v[64:79]
    v_mfma_f32_32x32x16_bf16 v[80:95], v[108:111], v[124:127], v[80:95]
    s_waitcnt vmcnt(8)
    s_barrier
    ds_read_b128 v[96:99], v20 offset:0
    ds_read_b128 v[100:103], v20 offset:4096
    ds_read_b128 v[112:115], v28 offset:0
    ds_read_b128 v[116:119], v28 offset:4096
    ds_read_b128 v[104:107], v21 offset:0
    ds_read_b128 v[108:111], v21 offset:4096
    ds_read_b128 v[120:123], v29 offset:0
    ds_read_b128 v[124:127], v29 offset:4096
    s_waitcnt lgkmcnt(4)
    v_mfma_f32_32x32x16_bf16 v[32:47], v[96:99], v[112:115], v[32:47]
    v_mfma_f32_32x32x16_bf16 v[48:63], v[96:99], v[116:119], v[48:63]
    v_mfma_f32_32x32x16_bf16 v[64:79], v[100:103], v[112:115], v[64:79]
    v_mfma_f32_32x32x16_bf16 v[80:95], v[100:103], v[116:119], v[80:95]
    ds_read_b128 v[96:99], v22 offset:0
    ds_read_b128 v[100:103], v22 offset:4096
    ds_read_b128 v[112:115], v30 offset:0
    ds_read_b128 v[116:119], v30 offset:4096
    s_waitcnt lgkmcnt(4)
    v_mfma_f32_32x32x16_bf16 v[32:47], v[104:107], v[120:123], v[32:47]
    v_mfma_f32_32x32x16_bf16 v[48:63], v[104:107], v[124:127], v[48:63]
    v_mfma_f32_32x32x16_bf16 v[64:79], v[108:111], v[120:123], v[64:79]
    v_mfma_f32_32x32x16_bf16 v[80:95], v[108:111], v[124:127], v[80:95]
    ds_read_b128 v[104:107], v23 offset:0
    ds_read_b128 v[108:111], v23 offset:4096
    ds_read_b128 v[120:123], v31 offset:0
    ds_read_b128 v[124:127], v31 offset:4096
    s_waitcnt lgkmcnt(4)
    v_mfma_f32_32x32x16_bf16 v[32:47], v[96:99], v[112:115], v[32:47]
    v_mfma_f32_32x32x16_bf16 v[48:63], v[96:99], v[116:119], v[48:63]
    v_mfma_f32_32x32x16_bf16 v[64:79], v[100:103], v[112:115], v[64:79]
    v_mfma_f32_32x32x16_bf16 v[80:95], v[100:103], v[116:119], v[80:95]
    s_waitcnt lgkmcnt(0)
    v_mfma_f32_32x32x16_bf16 v[32:47], v[104:107], v[120:123], v[32:47]
    v_mfma_f32_32x32x16_bf16 v[48:63], v[104:107], v[124:127], v[48:63]
    v_mfma_f32_32x32x16_bf16 v[64:79], v[108:111], v[120:123], v[64:79]
    v_mfma_f32_32x32x16_bf16 v[80:95], v[108:111], v[124:127], v[80:95]
    s_waitcnt vmcnt(0)
    s_barrier
    ds_read_b128 v[96:99], v16 offset:0
    ds_read_b128 v[100:103], v16 offset:4096
    ds_read_b128 v[112:115], v24 offset:0
    ds_read_b128 v[116:119], v24 offset:4096
    ds_read_b128 v[104:107], v17 offset:0
    ds_read_b128 v[108:111], v17 offset:4096
    ds_read_b128 v[120:123], v25 offset:0
    ds_read_b128 v[124:127], v25 offset:4096
    s_waitcnt lgkmcnt(4)
    v_mfma_f32_32x32x16_bf16 v[32:47], v[96:99], v[112:115], v[32:47]
    v_mfma_f32_32x32x16_bf16 v[48:63], v[96:99], v[116:119], v[48:63]
    v_mfma_f32_32x32x16_bf16 v[64:79], v[100:103], v[112:115], v[64:79]
    v_mfma_f32_32x32x16_bf16 v[80:95], v[100:103], v[116:119], v[80:95]
    ds_read_b128 v[96:99], v18 offset:0
    ds_read_b128 v[100:103], v18 offset:4096
    ds_read_b128 v[112:115], v26 offset:0
    ds_read_b128 v[116:119], v26 offset:4096
    s_waitcnt lgkmcnt(4)
    v_mfma_f32_32x32x16_bf16 v[32:47], v[104:107], v[120:123], v[32:47]
    v_mfma_f32_32x32x16_bf16 v[48:63], v[104:107], v[124:127], v[48:63]
    v_mfma_f32_32x32x16_bf16 v[64:79], v[108:111], v[120:123], v[64:79]
    v_mfma_f32_32x32x16_bf16 v[80:95], v[108:111], v[124:127], v[80:95]
    ds_read_b128 v[104:107], v19 offset:0
    ds_read_b128 v[108:111], v19 offset:4096
    ds_read_b128 v[120:123], v27 offset:0
    ds_read_b128 v[124:127], v27 offset:4096
    s_waitcnt lgkmcnt(4)
    v_mfma_f32_32x32x16_bf16 v[32:47], v[96:99], v[112:115], v[32:47]
    v_mfma_f32_32x32x16_bf16 v[48:63], v[96:99], v[116:119], v[48:63]
    v_mfma_f32_32x32x16_bf16 v[64:79], v[100:103], v[112:115], v[64:79]
    v_mfma_f32_32x32x16_bf16 v[80:95], v[100:103], v[116:119], v[80:95]
    s_waitcnt lgkmcnt(0)
    v_mfma_f32_32x32x16_bf16 v[32:47], v[104:107], v[120:123], v[32:47]
    v_mfma_f32_32x32x16_bf16 v[48:63], v[104:107], v[124:127], v[48:63]
    v_mfma_f32_32x32x16_bf16 v[64:79], v[108:111], v[120:123], v[64:79]
    v_mfma_f32_32x32x16_bf16 v[80:95], v[108:111], v[124:127], v[80:95]
    s_lshl_b32 s24, s21, 1
    s_add_u32 s24, s24, s23
    s_lshl_b32 s25, s24, 5
    v_and_b32 v4, 31, v2
    v_add_u32 v4, s25, v4
    v_lshlrev_b32 v5, 1, v4
    s_lshl_b32 s25, s20, 1
    s_add_u32 s25, s25, s22
    s_mul_i32 s26, s25, 14
    s_add_u32 s26, s26, s24
    s_lshl_b32 s26, s26, 14
    s_add_u32 s26, s26, 6291456
    v_lshlrev_b32 v10, 4, v2
    v_mov_b32 v12, 0
    v_mov_b32 v13, 0
    v_mul_f32 v14, v141, v48
    v_mul_f32 v15, v141, v32
    v_fma_f32 v32, v140, v32, -v14
    v_fma_f32 v48, v140, v48, v15
    v_fma_f32 v14, v138, v12, v32
    v_fma_f32 v15, v138, v13, v48
    v_fma_f32 v15, v139, v12, v15
    v_fma_f32 v12, -v139, v13, v14
    v_mov_b32 v13, v15
    v_mul_f32 v14, v141, v49
    v_mul_f32 v15, v141, v33
    v_fma_f32 v33, v140, v33, -v14
    v_fma_f32 v49, v140, v49, v15
    v_fma_f32 v14, v138, v12, v33
    v_fma_f32 v15, v138, v13, v49
    v_fma_f32 v15, v139, v12, v15
    v_fma_f32 v12, -v139, v13, v14
    v_mov_b32 v13, v15
    v_mul_f32 v14, v141, v50
    v_mul_f32 v15, v141, v34
    v_fma_f32 v34, v140, v34, -v14
    v_fma_f32 v50, v140, v50, v15
    v_fma_f32 v14, v138, v12, v34
    v_fma_f32 v15, v138, v13, v50
    v_fma_f32 v15, v139, v12, v15
    v_fma_f32 v12, -v139, v13, v14
    v_mov_b32 v13, v15
    v_mul_f32 v14, v141, v51
    v_mul_f32 v15, v141, v35
    v_fma_f32 v35, v140, v35, -v14
    v_fma_f32 v51, v140, v51, v15
    v_fma_f32 v14, v138, v12, v35
    v_fma_f32 v15, v138, v13, v51
    v_fma_f32 v15, v139, v12, v15
    v_fma_f32 v12, -v139, v13, v14
    v_mov_b32 v13, v15
    v_mul_f32 v14, v141, v52
    v_mul_f32 v15, v141, v36
    v_fma_f32 v36, v140, v36, -v14
    v_fma_f32 v52, v140, v52, v15
    v_fma_f32 v14, v138, v12, v36
    v_fma_f32 v15, v138, v13, v52
    v_fma_f32 v15, v139, v12, v15
    v_fma_f32 v12, -v139, v13, v14
    v_mov_b32 v13, v15
    v_mul_f32 v14, v141, v53
    v_mul_f32 v15, v141, v37
    v_fma_f32 v37, v140, v37, -v14
    v_fma_f32 v53, v140, v53, v15
    v_fma_f32 v14, v138, v12, v37
    v_fma_f32 v15, v138, v13, v53
    v_fma_f32 v15, v139, v12, v15
    v_fma_f32 v12, -v139, v13, v14
    v_mov_b32 v13, v15
    v_mul_f32 v14, v141, v54
    v_mul_f32 v15, v141, v38
    v_fma_f32 v38, v140, v38, -v14
    v_fma_f32 v54, v140, v54, v15
    v_fma_f32 v14, v138, v12, v38
    v_fma_f32 v15, v138, v13, v54
    v_fma_f32 v15, v139, v12, v15
    v_fma_f32 v12, -v139, v13, v14
    v_mov_b32 v13, v15
    v_mul_f32 v14, v141, v55
    v_mul_f32 v15, v141, v39
    v_fma_f32 v39, v140, v39, -v14
    v_fma_f32 v55, v140, v55, v15
    v_fma_f32 v14, v138, v12, v39
    v_fma_f32 v15, v138, v13, v55
    v_fma_f32 v15, v139, v12, v15
    v_fma_f32 v12, -v139, v13, v14
    v_mov_b32 v13, v15
    v_mul_f32 v14, v141, v56
    v_mul_f32 v15, v141, v40
    v_fma_f32 v40, v140, v40, -v14
    v_fma_f32 v56, v140, v56, v15
    v_fma_f32 v14, v138, v12, v40
    v_fma_f32 v15, v138, v13, v56
    v_fma_f32 v15, v139, v12, v15
    v_fma_f32 v12, -v139, v13, v14
    v_mov_b32 v13, v15
    v_mul_f32 v14, v141, v57
    v_mul_f32 v15, v141, v41
    v_fma_f32 v41, v140, v41, -v14
    v_fma_f32 v57, v140, v57, v15
    v_fma_f32 v14, v138, v12, v41
    v_fma_f32 v15, v138, v13, v57
    v_fma_f32 v15, v139, v12, v15
    v_fma_f32 v12, -v139, v13, v14
    v_mov_b32 v13, v15
    v_mul_f32 v14, v141, v58
    v_mul_f32 v15, v141, v42
    v_fma_f32 v42, v140, v42, -v14
    v_fma_f32 v58, v140, v58, v15
    v_fma_f32 v14, v138, v12, v42
    v_fma_f32 v15, v138, v13, v58
    v_fma_f32 v15, v139, v12, v15
    v_fma_f32 v12, -v139, v13, v14
    v_mov_b32 v13, v15
    v_mul_f32 v14, v141, v59
    v_mul_f32 v15, v141, v43
    v_fma_f32 v43, v140, v43, -v14
    v_fma_f32 v59, v140, v59, v15
    v_fma_f32 v14, v138, v12, v43
    v_fma_f32 v15, v138, v13, v59
    v_fma_f32 v15, v139, v12, v15
    v_fma_f32 v12, -v139, v13, v14
    v_mov_b32 v13, v15
    v_mul_f32 v14, v141, v60
    v_mul_f32 v15, v141, v44
    v_fma_f32 v44, v140, v44, -v14
    v_fma_f32 v60, v140, v60, v15
    v_fma_f32 v14, v138, v12, v44
    v_fma_f32 v15, v138, v13, v60
    v_fma_f32 v15, v139, v12, v15
    v_fma_f32 v12, -v139, v13, v14
    v_mov_b32 v13, v15
    v_mul_f32 v14, v141, v61
    v_mul_f32 v15, v141, v45
    v_fma_f32 v45, v140, v45, -v14
    v_fma_f32 v61, v140, v61, v15
    v_fma_f32 v14, v138, v12, v45
    v_fma_f32 v15, v138, v13, v61
    v_fma_f32 v15, v139, v12, v15
    v_fma_f32 v12, -v139, v13, v14
    v_mov_b32 v13, v15
    v_mul_f32 v14, v141, v62
    v_mul_f32 v15, v141, v46
    v_fma_f32 v46, v140, v46, -v14
    v_fma_f32 v62, v140, v62, v15
    v_fma_f32 v14, v138, v12, v46
    v_fma_f32 v15, v138, v13, v62
    v_fma_f32 v15, v139, v12, v15
    v_fma_f32 v12, -v139, v13, v14
    v_mov_b32 v13, v15
    v_mul_f32 v14, v141, v63
    v_mul_f32 v15, v141, v47
    v_fma_f32 v47, v140, v47, -v14
    v_fma_f32 v63, v140, v63, v15
    v_fma_f32 v14, v138, v12, v47
    v_fma_f32 v15, v138, v13, v63
    v_fma_f32 v15, v139, v12, v15
    v_fma_f32 v12, -v139, v13, v14
    v_mov_b32 v13, v15
    s_add_u32 s29, s26, 0
    buffer_store_dwordx4 v[32:35], v10, s[12:15], s29 offen offset:0 sc0 sc1
    buffer_store_dwordx4 v[36:39], v10, s[12:15], s29 offen offset:1024 sc0 sc1
    buffer_store_dwordx4 v[40:43], v10, s[12:15], s29 offen offset:2048 sc0 sc1
    buffer_store_dwordx4 v[44:47], v10, s[12:15], s29 offen offset:3072 sc0 sc1
    s_add_u32 s29, s26, 8192
    buffer_store_dwordx4 v[48:51], v10, s[12:15], s29 offen offset:0 sc0 sc1
    buffer_store_dwordx4 v[52:55], v10, s[12:15], s29 offen offset:1024 sc0 sc1
    buffer_store_dwordx4 v[56:59], v10, s[12:15], s29 offen offset:2048 sc0 sc1
    buffer_store_dwordx4 v[60:63], v10, s[12:15], s29 offen offset:3072 sc0 sc1
    v_mul_f32 v14, v141, v80
    v_mul_f32 v15, v141, v64
    v_fma_f32 v64, v140, v64, -v14
    v_fma_f32 v80, v140, v80, v15
    v_fma_f32 v14, v138, v12, v64
    v_fma_f32 v15, v138, v13, v80
    v_fma_f32 v15, v139, v12, v15
    v_fma_f32 v12, -v139, v13, v14
    v_mov_b32 v13, v15
    v_mul_f32 v14, v141, v81
    v_mul_f32 v15, v141, v65
    v_fma_f32 v65, v140, v65, -v14
    v_fma_f32 v81, v140, v81, v15
    v_fma_f32 v14, v138, v12, v65
    v_fma_f32 v15, v138, v13, v81
    v_fma_f32 v15, v139, v12, v15
    v_fma_f32 v12, -v139, v13, v14
    v_mov_b32 v13, v15
    v_mul_f32 v14, v141, v82
    v_mul_f32 v15, v141, v66
    v_fma_f32 v66, v140, v66, -v14
    v_fma_f32 v82, v140, v82, v15
    v_fma_f32 v14, v138, v12, v66
    v_fma_f32 v15, v138, v13, v82
    v_fma_f32 v15, v139, v12, v15
    v_fma_f32 v12, -v139, v13, v14
    v_mov_b32 v13, v15
    v_mul_f32 v14, v141, v83
    v_mul_f32 v15, v141, v67
    v_fma_f32 v67, v140, v67, -v14
    v_fma_f32 v83, v140, v83, v15
    v_fma_f32 v14, v138, v12, v67
    v_fma_f32 v15, v138, v13, v83
    v_fma_f32 v15, v139, v12, v15
    v_fma_f32 v12, -v139, v13, v14
    v_mov_b32 v13, v15
    v_mul_f32 v14, v141, v84
    v_mul_f32 v15, v141, v68
    v_fma_f32 v68, v140, v68, -v14
    v_fma_f32 v84, v140, v84, v15
    v_fma_f32 v14, v138, v12, v68
    v_fma_f32 v15, v138, v13, v84
    v_fma_f32 v15, v139, v12, v15
    v_fma_f32 v12, -v139, v13, v14
    v_mov_b32 v13, v15
    v_mul_f32 v14, v141, v85
    v_mul_f32 v15, v141, v69
    v_fma_f32 v69, v140, v69, -v14
    v_fma_f32 v85, v140, v85, v15
    v_fma_f32 v14, v138, v12, v69
    v_fma_f32 v15, v138, v13, v85
    v_fma_f32 v15, v139, v12, v15
    v_fma_f32 v12, -v139, v13, v14
    v_mov_b32 v13, v15
    v_mul_f32 v14, v141, v86
    v_mul_f32 v15, v141, v70
    v_fma_f32 v70, v140, v70, -v14
    v_fma_f32 v86, v140, v86, v15
    v_fma_f32 v14, v138, v12, v70
    v_fma_f32 v15, v138, v13, v86
    v_fma_f32 v15, v139, v12, v15
    v_fma_f32 v12, -v139, v13, v14
    v_mov_b32 v13, v15
    v_mul_f32 v14, v141, v87
    v_mul_f32 v15, v141, v71
    v_fma_f32 v71, v140, v71, -v14
    v_fma_f32 v87, v140, v87, v15
    v_fma_f32 v14, v138, v12, v71
    v_fma_f32 v15, v138, v13, v87
    v_fma_f32 v15, v139, v12, v15
    v_fma_f32 v12, -v139, v13, v14
    v_mov_b32 v13, v15
    v_mul_f32 v14, v141, v88
    v_mul_f32 v15, v141, v72
    v_fma_f32 v72, v140, v72, -v14
    v_fma_f32 v88, v140, v88, v15
    v_fma_f32 v14, v138, v12, v72
    v_fma_f32 v15, v138, v13, v88
    v_fma_f32 v15, v139, v12, v15
    v_fma_f32 v12, -v139, v13, v14
    v_mov_b32 v13, v15
    v_mul_f32 v14, v141, v89
    v_mul_f32 v15, v141, v73
    v_fma_f32 v73, v140, v73, -v14
    v_fma_f32 v89, v140, v89, v15
    v_fma_f32 v14, v138, v12, v73
    v_fma_f32 v15, v138, v13, v89
    v_fma_f32 v15, v139, v12, v15
    v_fma_f32 v12, -v139, v13, v14
    v_mov_b32 v13, v15
    v_mul_f32 v14, v141, v90
    v_mul_f32 v15, v141, v74
    v_fma_f32 v74, v140, v74, -v14
    v_fma_f32 v90, v140, v90, v15
    v_fma_f32 v14, v138, v12, v74
    v_fma_f32 v15, v138, v13, v90
    v_fma_f32 v15, v139, v12, v15
    v_fma_f32 v12, -v139, v13, v14
    v_mov_b32 v13, v15
    v_mul_f32 v14, v141, v91
    v_mul_f32 v15, v141, v75
    v_fma_f32 v75, v140, v75, -v14
    v_fma_f32 v91, v140, v91, v15
    v_fma_f32 v14, v138, v12, v75
    v_fma_f32 v15, v138, v13, v91
    v_fma_f32 v15, v139, v12, v15
    v_fma_f32 v12, -v139, v13, v14
    v_mov_b32 v13, v15
    v_mul_f32 v14, v141, v92
    v_mul_f32 v15, v141, v76
    v_fma_f32 v76, v140, v76, -v14
    v_fma_f32 v92, v140, v92, v15
    v_fma_f32 v14, v138, v12, v76
    v_fma_f32 v15, v138, v13, v92
    v_fma_f32 v15, v139, v12, v15
    v_fma_f32 v12, -v139, v13, v14
    v_mov_b32 v13, v15
    v_mul_f32 v14, v141, v93
    v_mul_f32 v15, v141, v77
    v_fma_f32 v77, v140, v77, -v14
    v_fma_f32 v93, v140, v93, v15
    v_fma_f32 v14, v138, v12, v77
    v_fma_f32 v15, v138, v13, v93
    v_fma_f32 v15, v139, v12, v15
    v_fma_f32 v12, -v139, v13, v14
    v_mov_b32 v13, v15
    v_mul_f32 v14, v141, v94
    v_mul_f32 v15, v141, v78
    v_fma_f32 v78, v140, v78, -v14
    v_fma_f32 v94, v140, v94, v15
    v_fma_f32 v14, v138, v12, v78
    v_fma_f32 v15, v138, v13, v94
    v_fma_f32 v15, v139, v12, v15
    v_fma_f32 v12, -v139, v13, v14
    v_mov_b32 v13, v15
    v_mul_f32 v14, v141, v95
    v_mul_f32 v15, v141, v79
    v_fma_f32 v79, v140, v79, -v14
    v_fma_f32 v95, v140, v95, v15
    v_fma_f32 v14, v138, v12, v79
    v_fma_f32 v15, v138, v13, v95
    v_fma_f32 v15, v139, v12, v15
    v_fma_f32 v12, -v139, v13, v14
    v_mov_b32 v13, v15
    s_add_u32 s29, s26, 4096
    buffer_store_dwordx4 v[64:67], v10, s[12:15], s29 offen offset:0 sc0 sc1
    buffer_store_dwordx4 v[68:71], v10, s[12:15], s29 offen offset:1024 sc0 sc1
    buffer_store_dwordx4 v[72:75], v10, s[12:15], s29 offen offset:2048 sc0 sc1
    buffer_store_dwordx4 v[76:79], v10, s[12:15], s29 offen offset:3072 sc0 sc1
    s_add_u32 s29, s26, 12288
    buffer_store_dwordx4 v[80:83], v10, s[12:15], s29 offen offset:0 sc0 sc1
    buffer_store_dwordx4 v[84:87], v10, s[12:15], s29 offen offset:1024 sc0 sc1
    buffer_store_dwordx4 v[88:91], v10, s[12:15], s29 offen offset:2048 sc0 sc1
    buffer_store_dwordx4 v[92:95], v10, s[12:15], s29 offen offset:3072 sc0 sc1
    v_mul_f32 v14, v139, v139
    v_mul_f32 v139, v138, v139
    v_fma_f32 v138, v138, v138, -v14
    v_add_f32 v139, v139, v139
    v_mul_f32 v14, v139, v139
    v_mul_f32 v139, v138, v139
    v_fma_f32 v138, v138, v138, -v14
    v_add_f32 v139, v139, v139
    v_mul_f32 v14, v139, v139
    v_mul_f32 v139, v138, v139
    v_fma_f32 v138, v138, v138, -v14
    v_add_f32 v139, v139, v139
    v_mul_f32 v14, v139, v139
    v_mul_f32 v139, v138, v139
    v_fma_f32 v138, v138, v138, -v14
    v_add_f32 v139, v139, v139
    v_mul_f32 v14, v139, v139
    v_mul_f32 v139, v138, v139
    v_fma_f32 v138, v138, v138, -v14
    v_add_f32 v139, v139, v139
    v_mov_b32 v16, v12
    v_mov_b32 v17, v12
    v_mov_b32 v18, v13
    v_mov_b32 v19, v13
    s_nop 1
    v_permlane32_swap_b32 v16, v17
    v_permlane32_swap_b32 v18, v19
    s_nop 1
    v_fma_f32 v20, v138, v16, v17
    v_fma_f32 v21, v138, v18, v19
    v_fma_f32 v20, -v139, v18, v20
    v_fma_f32 v21, v139, v16, v21
    s_mov_b32 s30, 0
    s_mov_b32 s31, -1
    v_cndmask_b32 v20, v12, v20, s[30:31]
    v_cndmask_b32 v21, v13, v21, s[30:31]
    v_lshrrev_b32 v5, 5, v2
    v_mul_u32_u24 v5, 448, v5
    v_add_u32 v5, v5, v4
    v_lshlrev_b32 v5, 3, v5
    s_mul_i32 s29, s25, 7168
    s_add_u32 s29, s29, 13631488
    buffer_store_dwordx2 v[20:21], v5, s[12:15], s29 offen sc0 sc1
K1_END:
    s_endpgm
.globl k2_attn_kernel
.p2align 8
.type k2_attn_kernel,@function
k2_attn_kernel:
    s_cmp_ge_u32 s2, 368
    s_cbranch_scc1 K2_END
    s_load_dwordx2 s[40:41], s[0:1], 112
    v_lshrrev_b32 v1, 6, v0
    v_and_b32 v2, 63, v0
    s_nop 0
    v_readfirstlane_b32 s3, v1
    s_mov_b32 s30, 0
    s_mov_b32 s31, -1
    s_cmp_ge_u32 s2, 256
    s_cbranch_scc1 K2_SCAN
    s_setprio 2
    s_and_b32 s20, s2, 7
    s_lshl_b32 s20, s20, 1
    s_bfe_u32 s21, s2, 0x10003
    s_add_u32 s20, s20, s21
    s_lshr_b32 s21, s2, 4
    s_and_b32 s22, s3, 3
    s_lshr_b32 s23, s3, 2
    v_lshlrev_b32 v4, 4, v2
    s_lshl_b32 s24, s23, 13
    v_add_u32 v5, s24, v4
    s_lshl_b32 s25, s20, 6
    s_lshl_b32 s26, s21, 2
    s_add_u32 s26, s26, s22
    s_add_u32 s27, s25, s26
    s_lshl_b32 s27, s27, 11
    s_lshl_b32 s28, s23, 5
    s_add_u32 s28, s28, s25
    s_lshl_b32 s28, s28, 11
    s_add_u32 s33, s28, 2097152
    s_add_u32 s34, s28, 4194304
    s_cmp_lt_u32 s22, 2
    s_cselect_b32 s28, s33, s34
    s_and_b32 s29, s22, 1
    s_lshl_b32 s29, s29, 11
    s_add_u32 s28, s28, s29
    s_lshl_b32 s29, s22, 11
    s_add_u32 s29, s29, s24
    s_waitcnt lgkmcnt(0)
    s_mov_b32 s4, s40
    s_and_b32 s5, s41, 0xffff
    s_mov_b32 s6, 19660800
    s_mov_b32 s7, 0x00020000
    buffer_load_dwordx4 v[72:75], v4, s[4:7], s27 offen
    buffer_load_dwordx4 v[76:79], v4, s[4:7], s27 offen offset:1024
    s_add_u32 m0, s29, 0
    s_nop 0
    buffer_load_dwordx4 v4, s[4:7], s28 offen lds
    buffer_load_dwordx4 v4, s[4:7], s28 offen offset:1024 lds
    s_add_u32 s28, s28, 4096
    s_add_u32 m0, s29, 16384
    s_nop 0
    buffer_load_dwordx4 v4, s[4:7], s28 offen lds
    buffer_load_dwordx4 v4, s[4:7], s28 offen offset:1024 lds
    s_add_u32 s28, s28, 4096
    s_lshl_b32 s36, s21, 2
    s_add_u32 s36, s36, s25
    s_lshl_b32 s36, s36, 11
    s_add_u32 s36, s36, 2097152
    s_lshl_b32 s37, s23, 21
    s_add_u32 s36, s36, s37
    s_lshl_b32 s37, s22, 11
    s_add_u32 s36, s36, s37
    v_and_b32 v7, 15, v2
    v_lshlrev_b32 v7, 7, v7
    buffer_load_dword v112, v7, s[4:7], s36 offen
    s_add_u32 m0, s29, 32768
    s_nop 0
    buffer_load_dwordx4 v4, s[4:7], s28 offen lds
    buffer_load_dwordx4 v4, s[4:7], s28 offen offset:1024 lds
    s_add_u32 s28, s28, 4096
    v_mov_b32 v16, 0
    v_mov_b32 v17, 0
    v_mov_b32 v18, 0
    v_mov_b32 v19, 0
    v_mov_b32 v20, 0
    v_mov_b32 v21, 0
    v_mov_b32 v22, 0
    v_mov_b32 v23, 0
    v_mov_b32 v24, 0
    v_mov_b32 v25, 0
    v_mov_b32 v26, 0
    v_mov_b32 v27, 0
    v_mov_b32 v28, 0
    v_mov_b32 v29, 0
    v_mov_b32 v30, 0
    v_mov_b32 v31, 0
    s_waitcnt vmcnt(5)
    s_barrier
    ds_read_b128 v[80:83], v5 offset:0
    ds_read_b128 v[84:87], v5 offset:1024
    ds_read_b128 v[88:91], v5 offset:2048
    ds_read_b128 v[92:95], v5 offset:3072
    ds_read_b128 v[96:99], v5 offset:4096
    ds_read_b128 v[100:103], v5 offset:5120
    s_waitcnt lgkmcnt(4)
    v_mfma_f32_32x32x16_bf16 v[32:47], v[80:83], v[72:75], 0
    v_mfma_f32_32x32x16_bf16 v[32:47], v[84:87], v[76:79], v[32:47]
    s_nop 7
    s_nop 3
    v_max3_f32 v6, v32, v33, v34
    v_max3_f32 v6, v6, v35, v36
    v_max3_f32 v6, v6, v37, v38
    v_max3_f32 v6, v6, v39, v40
    v_max3_f32 v6, v6, v41, v42
    v_max3_f32 v6, v6, v43, v44
    v_max3_f32 v6, v6, v45, v46
    v_max_f32 v6, v6, v47
    v_mov_b32 v7, v6
    s_nop 1
    v_permlane32_swap_b32 v6, v7
    s_nop 1
    v_max_f32 v6, v6, v7
    v_cvt_pk_bf16_f32 v7, -v6, -v6
    v_and_b32 v7, 0xffff0000, v7
    v_sub_f32 v8, -v6, v7
    v_cvt_pk_bf16_f32 v8, v8, v8
    v_and_b32 v8, 0xffff0000, v8
    v_add_f32 v6, v7, v8
    v_sub_f32 v6, 0, v6
    v_lshrrev_b32 v9, 16, v7
    v_or_b32 v9, v9, v8
    v_cndmask_b32 v78, v78, v9, s[30:31]
    s_nop 1
    v_mfma_f32_32x32x16_bf16 v[32:47], v[80:83], v[72:75], 0
    v_mfma_f32_32x32x16_bf16 v[32:47], v[84:87], v[76:79], v[32:47]
    v_mov_b32 v68, 0
    v_mov_b32 v108, 0
    v_mov_b32 v69, 0
    v_mov_b32 v109, 0
    v_mov_b32 v70, 0
    v_mov_b32 v110, 0
    v_mov_b32 v71, 0
    v_mov_b32 v111, 0
    s_mov_b32 s35, 4
K2_LOOP:
    s_waitcnt vmcnt(2) lgkmcnt(0)
    s_barrier
    ds_read_b128 v[80:83], v5 offset:16384
    ds_read_b128 v[84:87], v5 offset:17408
    v_mfma_f32_32x32x16_bf16 v[16:31], v[108:111], v[68:71], v[16:31]
    v_exp_f32 v32, v32
    v_exp_f32 v33, v33
    v_exp_f32 v34, v34
    v_exp_f32 v35, v35
    ds_read_b128 v[104:107], v5 offset:6144
    ds_read_b128 v[108:111], v5 offset:7168
    v_cvt_pk_bf16_f32 v64, v32, v33
    v_cvt_pk_bf16_f32 v65, v34, v35
    v_mfma_f32_32x32x16_bf16 v[48:63], v[88:91], v[72:75], 0
    v_exp_f32 v36, v36
    v_exp_f32 v37, v37
    v_exp_f32 v38, v38
    v_exp_f32 v39, v39
    s_add_u32 m0, s29, 49152
    s_nop 0
    buffer_load_dwordx4 v4, s[4:7], s28 offen lds
    buffer_load_dwordx4 v4, s[4:7], s28 offen offset:1024 lds
    s_add_u32 s28, s28, 4096
    v_cvt_pk_bf16_f32 v66, v36, v37
    v_cvt_pk_bf16_f32 v67, v38, v39
    v_mfma_f32_32x32x16_bf16 v[48:63], v[92:95], v[76:79], v[48:63]
    v_exp_f32 v40, v40
    v_exp_f32 v41, v41
    v_exp_f32 v42, v42
    v_exp_f32 v43, v43
    v_cvt_pk_bf16_f32 v68, v40, v41
    v_cvt_pk_bf16_f32 v69, v42, v43
    v_mfma_f32_32x32x16_bf16 v[16:31], v[96:99], v[64:67], v[16:31]
    v_exp_f32 v44, v44
    v_exp_f32 v45, v45
    v_exp_f32 v46, v46
    v_exp_f32 v47, v47
    v_cvt_pk_bf16_f32 v70, v44, v45
    v_cvt_pk_bf16_f32 v71, v46, v47
    s_waitcnt lgkmcnt(0)
    ds_read_b128 v[88:91], v5 offset:18432
    ds_read_b128 v[92:95], v5 offset:19456
    v_mfma_f32_32x32x16_bf16 v[16:31], v[100:103], v[68:71], v[16:31]
    v_exp_f32 v48, v48
    v_exp_f32 v49, v49
    v_exp_f32 v50, v50
    v_exp_f32 v51, v51
    ds_read_b128 v[96:99], v5 offset:20480
    ds_read_b128 v[100:103], v5 offset:21504
    v_cvt_pk_bf16_f32 v64, v48, v49
    v_cvt_pk_bf16_f32 v65, v50, v51
    v_mfma_f32_32x32x16_bf16 v[32:47], v[80:83], v[72:75], 0
    v_exp_f32 v52, v52
    v_exp_f32 v53, v53
    v_exp_f32 v54, v54
    v_exp_f32 v55, v55
    v_cvt_pk_bf16_f32 v66, v52, v53
    v_cvt_pk_bf16_f32 v67, v54, v55
    v_mfma_f32_32x32x16_bf16 v[32:47], v[84:87], v[76:79], v[32:47]
    v_exp_f32 v56, v56
    v_exp_f32 v57, v57
    v_exp_f32 v58, v58
    v_exp_f32 v59, v59
    v_cvt_pk_bf16_f32 v68, v56, v57
    v_cvt_pk_bf16_f32 v69, v58, v59
    v_mfma_f32_32x32x16_bf16 v[16:31], v[104:107], v[64:67], v[16:31]
    v_exp_f32 v60, v60
    v_exp_f32 v61, v61
    v_exp_f32 v62, v62
    v_exp_f32 v63, v63
    v_cvt_pk_bf16_f32 v70, v60, v61
    v_cvt_pk_bf16_f32 v71, v62, v63
    s_waitcnt vmcnt(2) lgkmcnt(0)
    s_barrier
    ds_read_b128 v[80:83], v5 offset:32768
    ds_read_b128 v[84:87], v5 offset:33792
    v_mfma_f32_32x32x16_bf16 v[16:31], v[108:111], v[68:71], v[16:31]
    v_exp_f32 v32, v32
    v_exp_f32 v33, v33
    v_exp_f32 v34, v34
    v_exp_f32 v35, v35
    ds_read_b128 v[104:107], v5 offset:22528
    ds_read_b128 v[108:111], v5 offset:23552
    v_cvt_pk_bf16_f32 v64, v32, v33
    v_cvt_pk_bf16_f32 v65, v34, v35
    v_mfma_f32_32x32x16_bf16 v[48:63], v[88:91], v[72:75], 0
    v_exp_f32 v36, v36
    v_exp_f32 v37, v37
    v_exp_f32 v38, v38
    v_exp_f32 v39, v39
    s_add_u32 m0, s29, 0
    s_nop 0
    buffer_load_dwordx4 v4, s[4:7], s28 offen lds
    buffer_load_dwordx4 v4, s[4:7], s28 offen offset:1024 lds
    s_add_u32 s28, s28, 4096
    v_cvt_pk_bf16_f32 v66, v36, v37
    v_cvt_pk_bf16_f32 v67, v38, v39
    v_mfma_f32_32x32x16_bf16 v[48:63], v[92:95], v[76:79], v[48:63]
    v_exp_f32 v40, v40
    v_exp_f32 v41, v41
    v_exp_f32 v42, v42
    v_exp_f32 v43, v43
    v_cvt_pk_bf16_f32 v68, v40, v41
    v_cvt_pk_bf16_f32 v69, v42, v43
    v_mfma_f32_32x32x16_bf16 v[16:31], v[96:99], v[64:67], v[16:31]
    v_exp_f32 v44, v44
    v_exp_f32 v45, v45
    v_exp_f32 v46, v46
    v_exp_f32 v47, v47
    v_cvt_pk_bf16_f32 v70, v44, v45
    v_cvt_pk_bf16_f32 v71, v46, v47
    s_waitcnt lgkmcnt(0)
    ds_read_b128 v[88:91], v5 offset:34816
    ds_read_b128 v[92:95], v5 offset:35840
    v_mfma_f32_32x32x16_bf16 v[16:31], v[100:103], v[68:71], v[16:31]
    v_exp_f32 v48, v48
    v_exp_f32 v49, v49
    v_exp_f32 v50, v50
    v_exp_f32 v51, v51
    ds_read_b128 v[96:99], v5 offset:36864
    ds_read_b128 v[100:103], v5 offset:37888
    v_cvt_pk_bf16_f32 v64, v48, v49
    v_cvt_pk_bf16_f32 v65, v50, v51
    v_mfma_f32_32x32x16_bf16 v[32:47], v[80:83], v[72:75], 0
    v_exp_f32 v52, v52
    v_exp_f32 v53, v53
    v_exp_f32 v54, v54
    v_exp_f32 v55, v55
    v_cvt_pk_bf16_f32 v66, v52, v53
    v_cvt_pk_bf16_f32 v67, v54, v55
    v_mfma_f32_32x32x16_bf16 v[32:47], v[84:87], v[76:79], v[32:47]
    v_exp_f32 v56, v56
    v_exp_f32 v57, v57
    v_exp_f32 v58, v58
    v_exp_f32 v59, v59
    v_cvt_pk_bf16_f32 v68, v56, v57
    v_cvt_pk_bf16_f32 v69, v58, v59
    v_mfma_f32_32x32x16_bf16 v[16:31], v[104:107], v[64:67], v[16:31]
    v_exp_f32 v60, v60
    v_exp_f32 v61, v61
    v_exp_f32 v62, v62
    v_exp_f32 v63, v63
    v_cvt_pk_bf16_f32 v70, v60, v61
    v_cvt_pk_bf16_f32 v71, v62, v63
    s_waitcnt vmcnt(2) lgkmcnt(0)
    s_barrier
    ds_read_b128 v[80:83], v5 offset:49152
    ds_read_b128 v[84:87], v5 offset:50176
    v_mfma_f32_32x32x16_bf16 v[16:31], v[108:111], v[68:71], v[16:31]
    v_exp_f32 v32, v32
    v_exp_f32 v33, v33
    v_exp_f32 v34, v34
    v_exp_f32 v35, v35
    ds_read_b128 v[104:107], v5 offset:38912
    ds_read_b128 v[108:111], v5 offset:39936
    v_cvt_pk_bf16_f32 v64, v32, v33
    v_cvt_pk_bf16_f32 v65, v34, v35
    v_mfma_f32_32x32x16_bf16 v[48:63], v[88:91], v[72:75], 0
    v_exp_f32 v36, v36
    v_exp_f32 v37, v37
    v_exp_f32 v38, v38
    v_exp_f32 v39, v39
    s_add_u32 m0, s29, 16384
    s_nop 0
    buffer_load_dwordx4 v4, s[4:7], s28 offen lds
    buffer_load_dwordx4 v4, s[4:7], s28 offen offset:1024 lds
    s_add_u32 s28, s28, 4096
    v_cvt_pk_bf16_f32 v66, v36, v37
    v_cvt_pk_bf16_f32 v67, v38, v39
    v_mfma_f32_32x32x16_bf16 v[48:63], v[92:95], v[76:79], v[48:63]
    v_exp_f32 v40, v40
    v_exp_f32 v41, v41
    v_exp_f32 v42, v42
    v_exp_f32 v43, v43
    v_cvt_pk_bf16_f32 v68, v40, v41
    v_cvt_pk_bf16_f32 v69, v42, v43
    v_mfma_f32_32x32x16_bf16 v[16:31], v[96:99], v[64:67], v[16:31]
    v_exp_f32 v44, v44
    v_exp_f32 v45, v45
    v_exp_f32 v46, v46
    v_exp_f32 v47, v47
    v_cvt_pk_bf16_f32 v70, v44, v45
    v_cvt_pk_bf16_f32 v71, v46, v47
    s_waitcnt lgkmcnt(0)
    ds_read_b128 v[88:91], v5 offset:51200
    ds_read_b128 v[92:95], v5 offset:52224
    v_mfma_f32_32x32x16_bf16 v[16:31], v[100:103], v[68:71], v[16:31]
    v_exp_f32 v48, v48
    v_exp_f32 v49, v49
    v_exp_f32 v50, v50
    v_exp_f32 v51, v51
    ds_read_b128 v[96:99], v5 offset:53248
    ds_read_b128 v[100:103], v5 offset:54272
    v_cvt_pk_bf16_f32 v64, v48, v49
    v_cvt_pk_bf16_f32 v65, v50, v51
    v_mfma_f32_32x32x16_bf16 v[32:47], v[80:83], v[72:75], 0
    v_exp_f32 v52, v52
    v_exp_f32 v53, v53
    v_exp_f32 v54, v54
    v_exp_f32 v55, v55
    v_cvt_pk_bf16_f32 v66, v52, v53
    v_cvt_pk_bf16_f32 v67, v54, v55
    v_mfma_f32_32x32x16_bf16 v[32:47], v[84:87], v[76:79], v[32:47]
    v_exp_f32 v56, v56
    v_exp_f32 v57, v57
    v_exp_f32 v58, v58
    v_exp_f32 v59, v59
    v_cvt_pk_bf16_f32 v68, v56, v57
    v_cvt_pk_bf16_f32 v69, v58, v59
    v_mfma_f32_32x32x16_bf16 v[16:31], v[104:107], v[64:67], v[16:31]
    v_exp_f32 v60, v60
    v_exp_f32 v61, v61
    v_exp_f32 v62, v62
    v_exp_f32 v63, v63
    v_cvt_pk_bf16_f32 v70, v60, v61
    v_cvt_pk_bf16_f32 v71, v62, v63
    s_waitcnt vmcnt(2) lgkmcnt(0)
    s_barrier
    ds_read_b128 v[80:83], v5 offset:0
    ds_read_b128 v[84:87], v5 offset:1024
    v_mfma_f32_32x32x16_bf16 v[16:31], v[108:111], v[68:71], v[16:31]
    v_exp_f32 v32, v32
    v_exp_f32 v33, v33
    v_exp_f32 v34, v34
    v_exp_f32 v35, v35
    ds_read_b128 v[104:107], v5 offset:55296
    ds_read_b128 v[108:111], v5 offset:56320
    v_cvt_pk_bf16_f32 v64, v32, v33
    v_cvt_pk_bf16_f32 v65, v34, v35
    v_mfma_f32_32x32x16_bf16 v[48:63], v[88:91], v[72:75], 0
    v_exp_f32 v36, v36
    v_exp_f32 v37, v37
    v_exp_f32 v38, v38
    v_exp_f32 v39, v39
    s_add_u32 m0, s29, 32768
    s_nop 0
    buffer_load_dwordx4 v4, s[4:7], s28 offen lds
    buffer_load_dwordx4 v4, s[4:7], s28 offen offset:1024 lds
    s_add_u32 s28, s28, 4096
    v_cvt_pk_bf16_f32 v66, v36, v37
    v_cvt_pk_bf16_f32 v67, v38, v39
    v_mfma_f32_32x32x16_bf16 v[48:63], v[92:95], v[76:79], v[48:63]
    v_exp_f32 v40, v40
    v_exp_f32 v41, v41
    v_exp_f32 v42, v42
    v_exp_f32 v43, v43
    v_cvt_pk_bf16_f32 v68, v40, v41
    v_cvt_pk_bf16_f32 v69, v42, v43
    v_mfma_f32_32x32x16_bf16 v[16:31], v[96:99], v[64:67], v[16:31]
    v_exp_f32 v44, v44
    v_exp_f32 v45, v45
    v_exp_f32 v46, v46
    v_exp_f32 v47, v47
    v_cvt_pk_bf16_f32 v70, v44, v45
    v_cvt_pk_bf16_f32 v71, v46, v47
    s_waitcnt lgkmcnt(0)
    ds_read_b128 v[88:91], v5 offset:2048
    ds_read_b128 v[92:95], v5 offset:3072
    v_mfma_f32_32x32x16_bf16 v[16:31], v[100:103], v[68:71], v[16:31]
    v_exp_f32 v48, v48
    v_exp_f32 v49, v49
    v_exp_f32 v50, v50
    v_exp_f32 v51, v51
    ds_read_b128 v[96:99], v5 offset:4096
    ds_read_b128 v[100:103], v5 offset:5120
    v_cvt_pk_bf16_f32 v64, v48, v49
    v_cvt_pk_bf16_f32 v65, v50, v51
    v_mfma_f32_32x32x16_bf16 v[32:47], v[80:83], v[72:75], 0
    v_exp_f32 v52, v52
    v_exp_f32 v53, v53
    v_exp_f32 v54, v54
    v_exp_f32 v55, v55
    v_cvt_pk_bf16_f32 v66, v52, v53
    v_cvt_pk_bf16_f32 v67, v54, v55
    v_mfma_f32_32x32x16_bf16 v[32:47], v[84:87], v[76:79], v[32:47]
    v_exp_f32 v56, v56
    v_exp_f32 v57, v57
    v_exp_f32 v58, v58
    v_exp_f32 v59, v59
    v_cvt_pk_bf16_f32 v68, v56, v57
    v_cvt_pk_bf16_f32 v69, v58, v59
    v_mfma_f32_32x32x16_bf16 v[16:31], v[104:107], v[64:67], v[16:31]
    v_exp_f32 v60, v60
    v_exp_f32 v61, v61
    v_exp_f32 v62, v62
    v_exp_f32 v63, v63
    v_cvt_pk_bf16_f32 v70, v60, v61
    v_cvt_pk_bf16_f32 v71, v62, v63
    s_sub_u32 s35, s35, 1
    s_cmp_lg_u32 s35, 0
    s_cbranch_scc1 K2_LOOP
    s_nop 0
    v_mfma_f32_32x32x16_bf16 v[16:31], v[108:111], v[68:71], v[16:31]
    s_nop 7
    s_nop 3
    v_mov_b32 v7, 0x4e800000
    v_cmp_nlt_f32 vcc, v28, v7
    s_nop 1
    s_and_b64 vcc, vcc, s[30:31]
    s_cbranch_vccz K2_MERGE
    v_mov_b32 v8, 0xff800000
    s_mov_b32 s35, 32
    s_mov_b32 s36, s33
K2_FB1:
    buffer_load_dwordx4 v[80:83], v4, s[4:7], s36 offen
    buffer_load_dwordx4 v[84:87], v4, s[4:7], s36 offen offset:1024
    s_waitcnt vmcnt(0)
    v_mfma_f32_32x32x16_bf16 v[32:47], v[80:83], v[72:75], 0
    v_mfma_f32_32x32x16_bf16 v[32:47], v[84:87], v[76:79], v[32:47]
    s_nop 7
    s_nop 3
    v_max3_f32 v8, v8, v32, v33
    v_max3_f32 v8, v8, v34, v35
    v_max3_f32 v8, v8, v36, v37
    v_max3_f32 v8, v8, v38, v39
    v_max3_f32 v8, v8, v40, v41
    v_max3_f32 v8, v8, v42, v43
    v_max3_f32 v8, v8, v44, v45
    v_max3_f32 v8, v8, v46, v47
    s_add_u32 s36, s36, 2048
    s_sub_u32 s35, s35, 1
    s_cmp_lg_u32 s35, 0
    s_cbranch_scc1 K2_FB1
    v_mov_b32 v7, v8
    s_nop 1
    v_permlane32_swap_b32 v8, v7
    s_nop 1
    v_max_f32 v8, v8, v7
    v_add_f32 v6, v6, v8
    v_cvt_pk_bf16_f32 v7, -v6, -v6
    v_and_b32 v7, 0xffff0000, v7
    v_sub_f32 v8, -v6, v7
    v_cvt_pk_bf16_f32 v8, v8, v8
    v_and_b32 v8, 0xffff0000, v8
    v_add_f32 v6, v7, v8
    v_sub_f32 v6, 0, v6
    v_lshrrev_b32 v9, 16, v7
    v_or_b32 v9, v9, v8
    v_cndmask_b32 v78, v78, v9, s[30:31]
    v_mov_b32 v16, 0
    v_mov_b32 v17, 0
    v_mov_b32 v18, 0
    v_mov_b32 v19, 0
    v_mov_b32 v20, 0
    v_mov_b32 v21, 0
    v_mov_b32 v22, 0
    v_mov_b32 v23, 0
    v_mov_b32 v24, 0
    v_mov_b32 v25, 0
    v_mov_b32 v26, 0
    v_mov_b32 v27, 0
    v_mov_b32 v28, 0
    v_mov_b32 v29, 0
    v_mov_b32 v30, 0
    v_mov_b32 v31, 0
    s_mov_b32 s35, 32
    s_mov_b32 s36, s33
    s_mov_b32 s37, s34
K2_FB2:
    buffer_load_dwordx4 v[80:83], v4, s[4:7], s36 offen
    buffer_load_dwordx4 v[84:87], v4, s[4:7], s36 offen offset:1024
    buffer_load_dwordx4 v[96:99], v4, s[4:7], s37 offen
    buffer_load_dwordx4 v[100:103], v4, s[4:7], s37 offen offset:1024
    s_waitcnt vmcnt(0)
    v_mfma_f32_32x32x16_bf16 v[32:47], v[80:83], v[72:75], 0
    v_mfma_f32_32x32x16_bf16 v[32:47], v[84:87], v[76:79], v[32:47]
    s_nop 7
    s_nop 3
    v_exp_f32 v32, v32
    v_exp_f32 v33, v33
    v_exp_f32 v34, v34
    v_exp_f32 v35, v35
    v_exp_f32 v36, v36
    v_exp_f32 v37, v37
    v_exp_f32 v38, v38
    v_exp_f32 v39, v39
    v_exp_f32 v40, v40
    v_exp_f32 v41, v41
    v_exp_f32 v42, v42
    v_exp_f32 v43, v43
    v_exp_f32 v44, v44
    v_exp_f32 v45, v45
    v_exp_f32 v46, v46
    v_exp_f32 v47, v47
    s_nop 1
    v_cvt_pk_bf16_f32 v64, v32, v33
    v_cvt_pk_bf16_f32 v65, v34, v35
    v_cvt_pk_bf16_f32 v66, v36, v37
    v_cvt_pk_bf16_f32 v67, v38, v39
    v_cvt_pk_bf16_f32 v68, v40, v41
    v_cvt_pk_bf16_f32 v69, v42, v43
    v_cvt_pk_bf16_f32 v70, v44, v45
    v_cvt_pk_bf16_f32 v71, v46, v47
    s_nop 1
    v_mfma_f32_32x32x16_bf16 v[16:31], v[96:99], v[64:67], v[16:31]
    v_mfma_f32_32x32x16_bf16 v[16:31], v[100:103], v[68:71], v[16:31]
    s_add_u32 s36, s36, 2048
    s_add_u32 s37, s37, 2048
    s_sub_u32 s35, s35, 1
    s_cmp_lg_u32 s35, 0
    s_cbranch_scc1 K2_FB2
    s_nop 7
    s_nop 3
K2_MERGE:
    s_waitcnt vmcnt(0) lgkmcnt(0)
    s_barrier
    s_mul_i32 s36, s22, 5120
    v_add_u32 v8, s36, v4
    v_lshlrev_b32 v9, 2, v2
    v_add_u32 v9, s36, v9
    s_cmp_eq_u32 s23, 0
    s_cbranch_scc1 K2_M0
    ds_write_b128 v8, v[16:19] offset:0
    ds_write_b128 v8, v[20:23] offset:1024
    ds_write_b128 v8, v[24:27] offset:2048
    ds_write_b128 v8, v[28:31] offset:3072
    ds_write_b32 v9, v6 offset:4096
    s_waitcnt lgkmcnt(0)
    s_barrier
    s_endpgm
K2_M0:
    s_barrier
    ds_read_b128 v[32:35], v8 offset:0
    ds_read_b128 v[36:39], v8 offset:1024
    ds_read_b128 v[40:43], v8 offset:2048
    ds_read_b128 v[44:47], v8 offset:3072
    ds_read_b32 v10, v9 offset:4096
    s_waitcnt lgkmcnt(0)
    v_max_f32 v11, v6, v10
    v_sub_f32 v12, v6, v11
    v_sub_f32 v13, v10, v11
    v_exp_f32 v12, v12
    v_exp_f32 v13, v13
    s_nop 1
    v_mul_f32 v14, v12, v28
    v_fmac_f32 v14, v13, v44
    v_mov_b32 v15, v14
    s_nop 1
    v_permlane32_swap_b32 v15, v14
    s_nop 1
    v_rcp_f32 v14, v14
    s_nop 1
    v_mul_f32 v12, v12, v14
    v_mul_f32 v13, v13, v14
    v_mul_f32 v16, v12, v16
    v_fmac_f32 v16, v13, v32
    v_mul_f32 v17, v12, v17
    v_fmac_f32 v17, v13, v33
    v_mul_f32 v18, v12, v18
    v_fmac_f32 v18, v13, v34
    v_mul_f32 v19, v12, v19
    v_fmac_f32 v19, v13, v35
    v_mul_f32 v20, v12, v20
    v_fmac_f32 v20, v13, v36
    v_mul_f32 v21, v12, v21
    v_fmac_f32 v21, v13, v37
    v_mul_f32 v22, v12, v22
    v_fmac_f32 v22, v13, v38
    v_mul_f32 v23, v12, v23
    v_fmac_f32 v23, v13, v39
    v_mul_f32 v24, v12, v24
    v_fmac_f32 v24, v13, v40
    v_mul_f32 v25, v12, v25
    v_fmac_f32 v25, v13, v41
    v_mul_f32 v26, v12, v26
    v_fmac_f32 v26, v13, v42
    v_mul_f32 v27, v12, v27
    v_fmac_f32 v27, v13, v43
    v_mul_f32 v28, v12, v28
    v_fmac_f32 v28, v13, v44
    v_mul_f32 v29, v12, v29
    v_fmac_f32 v29, v13, v45
    v_mul_f32 v30, v12, v30
    v_fmac_f32 v30, v13, v46
    v_mul_f32 v31, v12, v31
    v_fmac_f32 v31, v13, v47
    v_cvt_pk_bf16_f32 v64, v16, v17
    v_cvt_pk_bf16_f32 v65, v18, v19
    v_cvt_pk_bf16_f32 v66, v20, v21
    v_cvt_pk_bf16_f32 v67, v22, v23
    v_cvt_pk_bf16_f32 v68, v24, v25
    v_cvt_pk_bf16_f32 v69, v26, v27
    v_cvt_pk_bf16_f32 v70, v28, v29
    v_cvt_pk_bf16_f32 v71, v30, v31
    v_mov_b32 v7, 0
    v_cndmask_b32 v70, v70, v7, s[30:31]
    v_cndmask_b32 v71, v71, v7, s[30:31]
    s_lshl_b32 s36, s26, 4
    s_add_u32 s36, s36, s20
    s_lshl_b32 s36, s36, 11
    s_add_u32 s36, s36, 17563648
    buffer_store_dwordx4 v[64:67], v4, s[4:7], s36 offen
    buffer_store_dwordx4 v[68:71], v4, s[4:7], s36 offen offset:1024
    s_endpgm
K2_SCAN:
    s_cmp_ge_u32 s3, 4
    s_cbranch_scc1 K2_END
    s_setprio 0
    s_load_dwordx4 s[48:51], s[0:1], 8
    s_load_dwordx2 s[52:53], s[0:1], 56
    s_load_dwordx4 s[44:47], s[0:1], 40
    s_load_dwordx2 s[42:43], s[0:1], 88
    s_load_dwordx2 s[54:55], s[0:1], 0
    s_sub_u32 s19, s2, 256
    s_and_b32 s20, s19, 7
    s_lshl_b32 s20, s20, 2
    s_add_u32 s20, s20, s3
    s_lshr_b32 s21, s19, 3
    s_mul_i32 s26, s20, 14
    s_add_u32 s26, s26, s21
    s_lshl_b32 s26, s26, 14
    s_add_u32 s26, s26, 6291456
    v_lshlrev_b32 v10, 4, v2
    s_lshl_b32 s25, s21, 5
    v_and_b32 v4, 31, v2
    v_add_u32 v4, s25, v4
    v_lshlrev_b32 v5, 1, v4
    v_lshrrev_b32 v3, 5, v2
    s_waitcnt lgkmcnt(0)
    s_mov_b32 s4, s40
    s_and_b32 s5, s41, 0xffff
    s_mov_b32 s6, 19660800
    s_mov_b32 s7, 0x00020000
    s_add_u32 s8, s40, 13631488
    s_addc_u32 s9, s41, 0
    s_and_b32 s9, s9, 0xffff
    s_mov_b32 s10, 229376
    s_mov_b32 s11, 0x00020000
    s_mov_b32 s56, s48
    s_and_b32 s57, s49, 0xffff
    s_mov_b32 s58, 896
    s_mov_b32 s59, 0x00020000
    s_mov_b32 s60, s50
    s_and_b32 s61, s51, 0xffff
    s_mov_b32 s62, 896
    s_mov_b32 s63, 0x00020000
    s_mov_b32 s64, s52
    s_and_b32 s65, s53, 0xffff
    s_mov_b32 s66, 896
    s_mov_b32 s67, 0x00020000
    s_sub_u32 s24, s20, 1
    v_sub_u32 v11, s24, v3
    s_movk_i32 s23, 7168
    v_mul_lo_u32 v11, v11, s23
    v_lshl_add_u32 v11, v4, 3, v11
    v_add_u32 v11, 3584, v11
    buffer_load_dwordx2 v[96:97], v11, s[8:11], 0 offen
    v_subrev_u32 v11, 14336, v11
    buffer_load_dwordx2 v[98:99], v11, s[8:11], 0 offen
    v_subrev_u32 v11, 14336, v11
    buffer_load_dwordx2 v[100:101], v11, s[8:11], 0 offen
    v_subrev_u32 v11, 14336, v11
    buffer_load_dwordx2 v[102:103], v11, s[8:11], 0 offen
    v_subrev_u32 v11, 14336, v11
    buffer_load_dwordx2 v[104:105], v11, s[8:11], 0 offen
    v_subrev_u32 v11, 14336, v11
    buffer_load_dwordx2 v[106:107], v11, s[8:11], 0 offen
    v_subrev_u32 v11, 14336, v11
    buffer_load_dwordx2 v[108:109], v11, s[8:11], 0 offen
    v_subrev_u32 v11, 14336, v11
    buffer_load_dwordx2 v[110:111], v11, s[8:11], 0 offen
    v_subrev_u32 v11, 14336, v11
    buffer_load_dwordx2 v[112:113], v11, s[8:11], 0 offen
    v_subrev_u32 v11, 14336, v11
    buffer_load_dwordx2 v[114:115], v11, s[8:11], 0 offen
    v_subrev_u32 v11, 14336, v11
    buffer_load_dwordx2 v[116:117], v11, s[8:11], 0 offen
    v_subrev_u32 v11, 14336, v11
    buffer_load_dwordx2 v[118:119], v11, s[8:11], 0 offen
    v_subrev_u32 v11, 14336, v11
    buffer_load_dwordx2 v[120:121], v11, s[8:11], 0 offen
    v_subrev_u32 v11, 14336, v11
    buffer_load_dwordx2 v[122:123], v11, s[8:11], 0 offen
    v_subrev_u32 v11, 14336, v11
    buffer_load_dwordx2 v[124:125], v11, s[8:11], 0 offen
    v_subrev_u32 v11, 14336, v11
    buffer_load_dwordx2 v[126:127], v11, s[8:11], 0 offen
    s_mul_i32 s24, s20, 7168
    v_lshlrev_b32 v12, 3, v4
    buffer_load_dwordx2 v[14:15], v12, s[8:11], s24 offen
    s_add_u32 s29, s26, 0
    buffer_load_dwordx4 v[32:35], v10, s[4:7], s29 offen offset:0
    s_add_u32 s29, s26, 0
    buffer_load_dwordx4 v[36:39], v10, s[4:7], s29 offen offset:1024
    s_add_u32 s29, s26, 0
    buffer_load_dwordx4 v[40:43], v10, s[4:7], s29 offen offset:2048
    s_add_u32 s29, s26, 0
    buffer_load_dwordx4 v[44:47], v10, s[4:7], s29 offen offset:3072
    s_add_u32 s29, s26, 4096
    buffer_load_dwordx4 v[48:51], v10, s[4:7], s29 offen offset:0
    s_add_u32 s29, s26, 4096
    buffer_load_dwordx4 v[52:55], v10, s[4:7], s29 offen offset:1024
    s_add_u32 s29, s26, 4096
    buffer_load_dwordx4 v[56:59], v10, s[4:7], s29 offen offset:2048
    s_add_u32 s29, s26, 4096
    buffer_load_dwordx4 v[60:63], v10, s[4:7], s29 offen offset:3072
    s_add_u32 s29, s26, 8192
    buffer_load_dwordx4 v[64:67], v10, s[4:7], s29 offen offset:0
    s_add_u32 s29, s26, 8192
    buffer_load_dwordx4 v[68:71], v10, s[4:7], s29 offen offset:1024
    s_add_u32 s29, s26, 8192
    buffer_load_dwordx4 v[72:75], v10, s[4:7], s29 offen offset:2048
    s_add_u32 s29, s26, 8192
    buffer_load_dwordx4 v[76:79], v10, s[4:7], s29 offen offset:3072
    s_add_u32 s29, s26, 12288
    buffer_load_dwordx4 v[80:83], v10, s[4:7], s29 offen offset:0
    s_add_u32 s29, s26, 12288
    buffer_load_dwordx4 v[84:87], v10, s[4:7], s29 offen offset:1024
    s_add_u32 s29, s26, 12288
    buffer_load_dwordx4 v[88:91], v10, s[4:7], s29 offen offset:2048
    s_add_u32 s29, s26, 12288
    buffer_load_dwordx4 v[92:95], v10, s[4:7], s29 offen offset:3072
    buffer_load_ushort v16, v5, s[56:59], 0 offen
    buffer_load_ushort v17, v5, s[60:63], 0 offen
    buffer_load_ushort v18, v5, s[64:67], 0 offen
    s_waitcnt vmcnt(0)
    v_lshlrev_b32 v16, 16, v16
    v_lshlrev_b32 v17, 16, v17
    v_lshlrev_b32 v18, 16, v18
    v_mul_f32 v18, 0x3fb8aa3b, v18
    v_exp_f32 v18, v18
    s_nop 1
    v_cvt_pk_bf16_f32 v18, v18, v18
    v_and_b32 v18, 0xffff0000, v18
    v_mul_f32 v19, v18, v16
    v_mul_f32 v20, v18, v17
    v_mul_f32 v19, 0x3fb8aa3b, v19
    v_exp_f32 v19, v19
    v_mul_f32 v20, 0.15915494, v20
    v_fract_f32 v20, v20
    v_sin_f32 v21, v20
    v_cos_f32 v22, v20
    s_nop 1
    v_mul_f32 v6, v19, v22
    v_mul_f32 v7, v19, v21
    s_lshl_b32 s16, s21, 2
    s_add_u32 s16, s16, s3
    s_lshl_b32 s16, s16, 13
    v_lshlrev_b32 v31, 7, v2
    v_add_u32 v31, s16, v31
    s_mov_b32 s12, s44
    s_and_b32 s13, s45, 0xffff
    s_mov_b32 s14, 401408
    s_mov_b32 s15, 0x00020000
    s_mov_b32 s36, s46
    s_and_b32 s37, s47, 0xffff
    s_mov_b32 s38, 401408
    s_mov_b32 s39, 0x00020000
    s_mov_b32 s32, s42
    s_and_b32 s33, s43, 0xffff
    s_mov_b32 s34, 401408
    s_mov_b32 s35, 0x00020000
    buffer_load_dword v28, v31, s[12:15], 0 offen
    buffer_load_dword v29, v31, s[36:39], 0 offen
    buffer_load_dword v30, v31, s[32:35], 0 offen
    s_mov_b32 s44, s54
    s_and_b32 s45, s55, 0xffff
    s_mov_b32 s46, 1835008
    s_mov_b32 s47, 0x00020000
    s_and_b32 s18, s19, 7
    s_mul_i32 s18, s18, 229376
    s_cmp_lt_u32 s16, 229376
    s_cselect_b32 s18, s18, 0x7ff00000
    v_add_u32 v1, s18, v31
    buffer_load_dword v23, v1, s[44:47], 0 offen
    v_mov_b32 v8, v6
    v_mov_b32 v9, v7
    v_mul_f32 v16, v9, v9
    v_mul_f32 v9, v8, v9
    v_fma_f32 v8, v8, v8, -v16
    v_add_f32 v9, v9, v9
    v_mul_f32 v16, v9, v9
    v_mul_f32 v9, v8, v9
    v_fma_f32 v8, v8, v8, -v16
    v_add_f32 v9, v9, v9
    v_mul_f32 v16, v9, v9
    v_mul_f32 v9, v8, v9
    v_fma_f32 v8, v8, v8, -v16
    v_add_f32 v9, v9, v9
    v_mul_f32 v16, v9, v9
    v_mul_f32 v9, v8, v9
    v_fma_f32 v8, v8, v8, -v16
    v_add_f32 v9, v9, v9
    v_mul_f32 v16, v9, v9
    v_mul_f32 v9, v8, v9
    v_fma_f32 v8, v8, v8, -v16
    v_add_f32 v9, v9, v9
    v_mul_f32 v16, v9, v9
    v_mul_f32 v13, v8, v9
    v_fma_f32 v12, v8, v8, -v16
    v_add_f32 v13, v13, v13
    v_mul_f32 v16, v13, v13
    v_mul_f32 v25, v12, v13
    v_fma_f32 v24, v12, v12, -v16
    v_add_f32 v25, v25, v25
    v_mov_b32 v26, v126
    v_mov_b32 v27, v127
    v_fma_f32 v16, v24, v26, v124
    v_fma_f32 v17, v24, v27, v125
    v_fma_f32 v16, -v25, v27, v16
    v_fma_f32 v27, v25, v26, v17
    v_mov_b32 v26, v16
    v_fma_f32 v16, v24, v26, v122
    v_fma_f32 v17, v24, v27, v123
    v_fma_f32 v16, -v25, v27, v16
    v_fma_f32 v27, v25, v26, v17
    v_mov_b32 v26, v16
    v_fma_f32 v16, v24, v26, v120
    v_fma_f32 v17, v24, v27, v121
    v_fma_f32 v16, -v25, v27, v16
    v_fma_f32 v27, v25, v26, v17
    v_mov_b32 v26, v16
    v_fma_f32 v16, v24, v26, v118
    v_fma_f32 v17, v24, v27, v119
    v_fma_f32 v16, -v25, v27, v16
    v_fma_f32 v27, v25, v26, v17
    v_mov_b32 v26, v16
    v_fma_f32 v16, v24, v26, v116
    v_fma_f32 v17, v24, v27, v117
    v_fma_f32 v16, -v25, v27, v16
    v_fma_f32 v27, v25, v26, v17
    v_mov_b32 v26, v16
    v_fma_f32 v16, v24, v26, v114
    v_fma_f32 v17, v24, v27, v115
    v_fma_f32 v16, -v25, v27, v16
    v_fma_f32 v27, v25, v26, v17
    v_mov_b32 v26, v16
    v_fma_f32 v16, v24, v26, v112
    v_fma_f32 v17, v24, v27, v113
    v_fma_f32 v16, -v25, v27, v16
    v_fma_f32 v27, v25, v26, v17
    v_mov_b32 v26, v16
    v_fma_f32 v16, v24, v26, v110
    v_fma_f32 v17, v24, v27, v111
    v_fma_f32 v16, -v25, v27, v16
    v_fma_f32 v27, v25, v26, v17
    v_mov_b32 v26, v16
    v_fma_f32 v16, v24, v26, v108
    v_fma_f32 v17, v24, v27, v109
    v_fma_f32 v16, -v25, v27, v16
    v_fma_f32 v27, v25, v26, v17
    v_mov_b32 v26, v16
    v_fma_f32 v16, v24, v26, v106
    v_fma_f32 v17, v24, v27, v107
    v_fma_f32 v16, -v25, v27, v16
    v_fma_f32 v27, v25, v26, v17
    v_mov_b32 v26, v16
    v_fma_f32 v16, v24, v26, v104
    v_fma_f32 v17, v24, v27, v105
    v_fma_f32 v16, -v25, v27, v16
    v_fma_f32 v27, v25, v26, v17
    v_mov_b32 v26, v16
    v_fma_f32 v16, v24, v26, v102
    v_fma_f32 v17, v24, v27, v103
    v_fma_f32 v16, -v25, v27, v16
    v_fma_f32 v27, v25, v26, v17
    v_mov_b32 v26, v16
    v_fma_f32 v16, v24, v26, v100
    v_fma_f32 v17, v24, v27, v101
    v_fma_f32 v16, -v25, v27, v16
    v_fma_f32 v27, v25, v26, v17
    v_mov_b32 v26, v16
    v_fma_f32 v16, v24, v26, v98
    v_fma_f32 v17, v24, v27, v99
    v_fma_f32 v16, -v25, v27, v16
    v_fma_f32 v27, v25, v26, v17
    v_mov_b32 v26, v16
    v_fma_f32 v16, v24, v26, v96
    v_fma_f32 v17, v24, v27, v97
    v_fma_f32 v16, -v25, v27, v16
    v_fma_f32 v27, v25, v26, v17
    v_mov_b32 v26, v16
    v_mov_b32 v16, v26
    v_mov_b32 v17, v27
    s_nop 1
    v_permlane32_swap_b32 v26, v16
    v_permlane32_swap_b32 v27, v17
    s_nop 1
    v_fma_f32 v26, v12, v16, v26
    v_fma_f32 v27, v12, v17, v27
    v_fma_f32 v26, -v13, v17, v26
    v_fma_f32 v27, v13, v16, v27
    v_fma_f32 v16, v8, v26, v14
    v_fma_f32 v17, v8, v27, v15
    v_fma_f32 v16, -v9, v27, v16
    v_fma_f32 v17, v9, v26, v17
    v_cndmask_b32 v26, v26, v16, s[30:31]
    v_cndmask_b32 v27, v27, v17, s[30:31]
    v_fma_f32 v32, v6, v26, v32
    v_fma_f32 v64, v6, v27, v64
    v_fma_f32 v32, -v7, v27, v32
    v_fma_f32 v64, v7, v26, v64
    v_fma_f32 v33, v6, v32, v33
    v_fma_f32 v65, v6, v64, v65
    v_fma_f32 v33, -v7, v64, v33
    v_fma_f32 v65, v7, v32, v65
    v_fma_f32 v34, v6, v33, v34
    v_fma_f32 v66, v6, v65, v66
    v_fma_f32 v34, -v7, v65, v34
    v_fma_f32 v66, v7, v33, v66
    v_fma_f32 v35, v6, v34, v35
    v_fma_f32 v67, v6, v66, v67
    v_fma_f32 v35, -v7, v66, v35
    v_fma_f32 v67, v7, v34, v67
    v_fma_f32 v36, v6, v35, v36
    v_fma_f32 v68, v6, v67, v68
    v_fma_f32 v36, -v7, v67, v36
    v_fma_f32 v68, v7, v35, v68
    v_fma_f32 v37, v6, v36, v37
    v_fma_f32 v69, v6, v68, v69
    v_fma_f32 v37, -v7, v68, v37
    v_fma_f32 v69, v7, v36, v69
    v_fma_f32 v38, v6, v37, v38
    v_fma_f32 v70, v6, v69, v70
    v_fma_f32 v38, -v7, v69, v38
    v_fma_f32 v70, v7, v37, v70
    v_fma_f32 v39, v6, v38, v39
    v_fma_f32 v71, v6, v70, v71
    v_fma_f32 v39, -v7, v70, v39
    v_fma_f32 v71, v7, v38, v71
    v_fma_f32 v40, v6, v39, v40
    v_fma_f32 v72, v6, v71, v72
    v_fma_f32 v40, -v7, v71, v40
    v_fma_f32 v72, v7, v39, v72
    v_fma_f32 v41, v6, v40, v41
    v_fma_f32 v73, v6, v72, v73
    v_fma_f32 v41, -v7, v72, v41
    v_fma_f32 v73, v7, v40, v73
    v_fma_f32 v42, v6, v41, v42
    v_fma_f32 v74, v6, v73, v74
    v_fma_f32 v42, -v7, v73, v42
    v_fma_f32 v74, v7, v41, v74
    v_fma_f32 v43, v6, v42, v43
    v_fma_f32 v75, v6, v74, v75
    v_fma_f32 v43, -v7, v74, v43
    v_fma_f32 v75, v7, v42, v75
    v_fma_f32 v44, v6, v43, v44
    v_fma_f32 v76, v6, v75, v76
    v_fma_f32 v44, -v7, v75, v44
    v_fma_f32 v76, v7, v43, v76
    v_fma_f32 v45, v6, v44, v45
    v_fma_f32 v77, v6, v76, v77
    v_fma_f32 v45, -v7, v76, v45
    v_fma_f32 v77, v7, v44, v77
    v_fma_f32 v46, v6, v45, v46
    v_fma_f32 v78, v6, v77, v78
    v_fma_f32 v46, -v7, v77, v46
    v_fma_f32 v78, v7, v45, v78
    v_fma_f32 v47, v6, v46, v47
    v_fma_f32 v79, v6, v78, v79
    v_fma_f32 v47, -v7, v78, v47
    v_fma_f32 v79, v7, v46, v79
    v_fma_f32 v48, v6, v47, v48
    v_fma_f32 v80, v6, v79, v80
    v_fma_f32 v48, -v7, v79, v48
    v_fma_f32 v80, v7, v47, v80
    v_fma_f32 v49, v6, v48, v49
    v_fma_f32 v81, v6, v80, v81
    v_fma_f32 v49, -v7, v80, v49
    v_fma_f32 v81, v7, v48, v81
    v_fma_f32 v50, v6, v49, v50
    v_fma_f32 v82, v6, v81, v82
    v_fma_f32 v50, -v7, v81, v50
    v_fma_f32 v82, v7, v49, v82
    v_fma_f32 v51, v6, v50, v51
    v_fma_f32 v83, v6, v82, v83
    v_fma_f32 v51, -v7, v82, v51
    v_fma_f32 v83, v7, v50, v83
    v_fma_f32 v52, v6, v51, v52
    v_fma_f32 v84, v6, v83, v84
    v_fma_f32 v52, -v7, v83, v52
    v_fma_f32 v84, v7, v51, v84
    v_fma_f32 v53, v6, v52, v53
    v_fma_f32 v85, v6, v84, v85
    v_fma_f32 v53, -v7, v84, v53
    v_fma_f32 v85, v7, v52, v85
    v_fma_f32 v54, v6, v53, v54
    v_fma_f32 v86, v6, v85, v86
    v_fma_f32 v54, -v7, v85, v54
    v_fma_f32 v86, v7, v53, v86
    v_fma_f32 v55, v6, v54, v55
    v_fma_f32 v87, v6, v86, v87
    v_fma_f32 v55, -v7, v86, v55
    v_fma_f32 v87, v7, v54, v87
    v_fma_f32 v56, v6, v55, v56
    v_fma_f32 v88, v6, v87, v88
    v_fma_f32 v56, -v7, v87, v56
    v_fma_f32 v88, v7, v55, v88
    v_fma_f32 v57, v6, v56, v57
    v_fma_f32 v89, v6, v88, v89
    v_fma_f32 v57, -v7, v88, v57
    v_fma_f32 v89, v7, v56, v89
    v_fma_f32 v58, v6, v57, v58
    v_fma_f32 v90, v6, v89, v90
    v_fma_f32 v58, -v7, v89, v58
    v_fma_f32 v90, v7, v57, v90
    v_fma_f32 v59, v6, v58, v59
    v_fma_f32 v91, v6, v90, v91
    v_fma_f32 v59, -v7, v90, v59
    v_fma_f32 v91, v7, v58, v91
    v_fma_f32 v60, v6, v59, v60
    v_fma_f32 v92, v6, v91, v92
    v_fma_f32 v60, -v7, v91, v60
    v_fma_f32 v92, v7, v59, v92
    v_fma_f32 v61, v6, v60, v61
    v_fma_f32 v93, v6, v92, v93
    v_fma_f32 v61, -v7, v92, v61
    v_fma_f32 v93, v7, v60, v93
    v_fma_f32 v62, v6, v61, v62
    v_fma_f32 v94, v6, v93, v94
    v_fma_f32 v62, -v7, v93, v62
    v_fma_f32 v94, v7, v61, v94
    v_fma_f32 v63, v6, v62, v63
    v_fma_f32 v95, v6, v94, v95
    v_fma_f32 v63, -v7, v94, v63
    v_fma_f32 v95, v7, v62, v95
    s_mul_i32 s24, s3, 6144
    v_and_b32 v8, 31, v2
    v_mul_u32_u24 v8, 192, v8
    v_lshl_add_u32 v8, v3, 6, v8
    v_add_u32 v8, s24, v8
    v_lshlrev_b32 v9, 3, v3
    v_bfe_u32 v12, v2, 2, 2
    v_add_u32 v9, v9, v12
    v_mul_u32_u24 v9, 192, v9
    v_bfe_u32 v12, v2, 4, 1
    v_lshl_add_u32 v9, v12, 5, v9
    v_and_b32 v12, 3, v2
    v_lshl_add_u32 v9, v12, 3, v9
    v_add_u32 v9, s24, v9
    s_mul_i32 s27, s20, 112
    s_lshl_b32 s28, s21, 1
    s_add_u32 s27, s27, s28
    s_lshl_b32 s27, s27, 10
    s_add_u32 s27, s27, 13893632
    v_cvt_pk_bf16_f32 v96, v32, v33
    v_cvt_pk_bf16_f32 v97, v34, v35
    v_cvt_pk_bf16_f32 v98, v36, v37
    v_cvt_pk_bf16_f32 v99, v38, v39
    v_cvt_pk_bf16_f32 v100, v40, v41
    v_cvt_pk_bf16_f32 v101, v42, v43
    v_cvt_pk_bf16_f32 v102, v44, v45
    v_cvt_pk_bf16_f32 v103, v46, v47
    v_cvt_pk_bf16_f32 v104, v48, v49
    v_cvt_pk_bf16_f32 v105, v50, v51
    v_cvt_pk_bf16_f32 v106, v52, v53
    v_cvt_pk_bf16_f32 v107, v54, v55
    v_cvt_pk_bf16_f32 v108, v56, v57
    v_cvt_pk_bf16_f32 v109, v58, v59
    v_cvt_pk_bf16_f32 v110, v60, v61
    v_cvt_pk_bf16_f32 v111, v62, v63
    ds_write_b128 v8, v[96:99] offset:0
    ds_write_b128 v8, v[100:103] offset:16
    ds_write_b128 v8, v[104:107] offset:32
    ds_write_b128 v8, v[108:111] offset:48
    s_waitcnt lgkmcnt(0)
    ds_read_b64_tr_b16 v[112:113], v9 offset:0
    ds_read_b64_tr_b16 v[114:115], v9 offset:768
    ds_read_b64_tr_b16 v[116:117], v9 offset:3072
    ds_read_b64_tr_b16 v[118:119], v9 offset:3840
    ds_read_b64_tr_b16 v[120:121], v9 offset:64
    ds_read_b64_tr_b16 v[122:123], v9 offset:832
    ds_read_b64_tr_b16 v[124:125], v9 offset:3136
    ds_read_b64_tr_b16 v[126:127], v9 offset:3904
    s_waitcnt lgkmcnt(0)
    s_add_u32 s29, s27, 0
    buffer_store_dwordx4 v[112:115], v10, s[4:7], s29 offen
    s_add_u32 s29, s27, 1024
    buffer_store_dwordx4 v[116:119], v10, s[4:7], s29 offen
    s_add_u32 s29, s27, 57344
    buffer_store_dwordx4 v[120:123], v10, s[4:7], s29 offen
    s_add_u32 s29, s27, 58368
    buffer_store_dwordx4 v[124:127], v10, s[4:7], s29 offen
    v_cvt_pk_bf16_f32 v96, -v64, -v65
    v_cvt_pk_bf16_f32 v97, -v66, -v67
    v_cvt_pk_bf16_f32 v98, -v68, -v69
    v_cvt_pk_bf16_f32 v99, -v70, -v71
    v_cvt_pk_bf16_f32 v100, -v72, -v73
    v_cvt_pk_bf16_f32 v101, -v74, -v75
    v_cvt_pk_bf16_f32 v102, -v76, -v77
    v_cvt_pk_bf16_f32 v103, -v78, -v79
    v_cvt_pk_bf16_f32 v104, -v80, -v81
    v_cvt_pk_bf16_f32 v105, -v82, -v83
    v_cvt_pk_bf16_f32 v106, -v84, -v85
    v_cvt_pk_bf16_f32 v107, -v86, -v87
    v_cvt_pk_bf16_f32 v108, -v88, -v89
    v_cvt_pk_bf16_f32 v109, -v90, -v91
    v_cvt_pk_bf16_f32 v110, -v92, -v93
    v_cvt_pk_bf16_f32 v111, -v94, -v95
    s_waitcnt lgkmcnt(0)
    ds_write_b128 v8, v[96:99] offset:0
    ds_write_b128 v8, v[100:103] offset:16
    ds_write_b128 v8, v[104:107] offset:32
    ds_write_b128 v8, v[108:111] offset:48
    s_waitcnt lgkmcnt(0)
    s_nop 0
    ds_read_b64_tr_b16 v[32:33], v9 offset:0
    ds_read_b64_tr_b16 v[34:35], v9 offset:768
    ds_read_b64_tr_b16 v[36:37], v9 offset:3072
    ds_read_b64_tr_b16 v[38:39], v9 offset:3840
    ds_read_b64_tr_b16 v[40:41], v9 offset:64
    ds_read_b64_tr_b16 v[42:43], v9 offset:832
    ds_read_b64_tr_b16 v[44:45], v9 offset:3136
    ds_read_b64_tr_b16 v[46:47], v9 offset:3904
    s_waitcnt lgkmcnt(0)
    s_add_u32 s29, s27, 28672
    buffer_store_dwordx4 v[32:35], v10, s[4:7], s29 offen
    s_add_u32 s29, s27, 29696
    buffer_store_dwordx4 v[36:39], v10, s[4:7], s29 offen
    s_add_u32 s29, s27, 86016
    buffer_store_dwordx4 v[40:43], v10, s[4:7], s29 offen
    s_add_u32 s29, s27, 87040
    buffer_store_dwordx4 v[44:47], v10, s[4:7], s29 offen
K2_END:
    s_endpgm
.globl k3_out_kernel
.p2align 8
.type k3_out_kernel,@function
k3_out_kernel:
    s_cmp_ge_u32 s2, 224
    s_cbranch_scc1 K3_END
    s_load_dwordx2 s[40:41], s[0:1], 112
    s_load_dwordx2 s[42:43], s[0:1], 96
    v_lshrrev_b32 v1, 6, v0
    v_and_b32 v2, 63, v0
    s_nop 0
    v_readfirstlane_b32 s3, v1
    s_cmp_ge_u32 s2, 112
    s_cselect_b32 s19, 112, 0
    s_sub_u32 s19, s2, s19
    s_and_b32 s20, s19, 7
    s_lshl_b32 s20, s20, 1
    s_bfe_u32 s21, s19, 0x10003
    s_add_u32 s20, s20, s21
    s_lshr_b32 s21, s19, 4
    s_lshl_b32 s22, s20, 2
    s_add_u32 s22, s22, s3
    v_lshlrev_b32 v4, 4, v2
    s_lshl_b32 s24, s22, 5
    v_and_b32 v5, 31, v2
    v_add_u32 v5, s24, v5
    v_lshrrev_b32 v3, 5, v2
    v_mul_u32_u24 v6, 3584, v5
    v_lshl_add_u32 v6, v3, 4, v6
    s_lshl_b32 s24, s21, 8
    v_add_u32 v6, s24, v6
    v_mov_b32 v32, 0
    v_mov_b32 v33, 0
    v_mov_b32 v34, 0
    v_mov_b32 v35, 0
    v_mov_b32 v36, 0
    v_mov_b32 v37, 0
    v_mov_b32 v38, 0
    v_mov_b32 v39, 0
    v_mov_b32 v40, 0
    v_mov_b32 v41, 0
    v_mov_b32 v42, 0
    v_mov_b32 v43, 0
    v_mov_b32 v44, 0
    v_mov_b32 v45, 0
    v_mov_b32 v46, 0
    v_mov_b32 v47, 0
    v_mov_b32 v48, 0
    v_mov_b32 v49, 0
    v_mov_b32 v50, 0
    v_mov_b32 v51, 0
    v_mov_b32 v52, 0
    v_mov_b32 v53, 0
    v_mov_b32 v54, 0
    v_mov_b32 v55, 0
    v_mov_b32 v56, 0
    v_mov_b32 v57, 0
    v_mov_b32 v58, 0
    v_mov_b32 v59, 0
    v_mov_b32 v60, 0
    v_mov_b32 v61, 0
    v_mov_b32 v62, 0
    v_mov_b32 v63, 0
    s_cmp_ge_u32 s2, 112
    s_cbranch_scc1 K3_B
    s_load_dwordx4 s[44:47], s[0:1], 40
    s_load_dwordx2 s[48:49], s[0:1], 0
    s_load_dwordx2 s[50:51], s[0:1], 64
    s_lshl_b32 s24, s21, 6
    s_lshl_b32 s25, s3, 4
    s_add_u32 s24, s24, s25
    v_lshrrev_b32 v8, 3, v2
    v_add_u32 v8, s24, v8
    v_mul_u32_u24 v8, 896, v8
    v_and_b32 v9, 7, v2
    v_lshrrev_b32 v10, 4, v2
    v_xor_b32 v9, v9, v10
    v_xor_b32 v10, 4, v9
    v_lshl_add_u32 v12, v9, 4, v8
    v_lshl_add_u32 v13, v10, 4, v8
    v_add_u32 v13, 7168, v13
    v_and_b32 v8, 31, v2
    v_lshrrev_b32 v9, 5, v2
    v_bfe_u32 v19, v8, 1, 3
    v_xor_b32 v9, v9, v19
    v_lshlrev_b32 v8, 7, v8
    v_xor_b32 v16, 0, v9
    v_lshl_add_u32 v16, v16, 4, v8
    v_xor_b32 v17, 2, v9
    v_lshl_add_u32 v17, v17, 4, v8
    v_xor_b32 v18, 4, v9
    v_lshl_add_u32 v18, v18, 4, v8
    v_xor_b32 v19, 6, v9
    v_lshl_add_u32 v19, v19, 4, v8
    v_add_u32 v20, 57344, v16
    v_add_u32 v21, 57344, v17
    v_add_u32 v22, 57344, v18
    v_add_u32 v23, 57344, v19
    v_mul_u32_u24 v24, 896, v5
    v_lshl_add_u32 v24, v3, 3, v24
    s_lshl_b32 s24, s21, 7
    v_add_u32 v24, s24, v24
    v_lshlrev_b32 v25, 3, v3
    v_add_u32 v25, s24, v25
    s_waitcnt lgkmcnt(0)
    s_mov_b32 s4, s40
    s_and_b32 s5, s41, 0xffff
    s_mov_b32 s6, 19660800
    s_mov_b32 s7, 0x00020000
    s_mov_b32 s8, s44
    s_and_b32 s9, s45, 0xffff
    s_mov_b32 s10, 401408
    s_mov_b32 s11, 0x00020000
    s_mov_b32 s12, s46
    s_and_b32 s13, s47, 0xffff
    s_mov_b32 s14, 401408
    s_mov_b32 s15, 0x00020000
    s_mov_b32 s16, s42
    s_and_b32 s17, s43, 0xffff
    s_mov_b32 s18, 7340032
    s_mov_b32 s19, 0x00020000
    s_mov_b32 s52, s48
    s_and_b32 s53, s49, 0xffff
    s_mov_b32 s54, 1835008
    s_mov_b32 s55, 0x00020000
    s_mov_b32 s56, s50
    s_and_b32 s57, s51, 0xffff
    s_mov_b32 s58, 896
    s_mov_b32 s59, 0x00020000
    s_mul_i32 s26, s22, 57344
    s_add_u32 s26, s26, 13893632
    s_lshl_b32 s27, s3, 11
    s_add_u32 m0, s27, 0
    s_movk_i32 s29, 0
    buffer_load_dwordx4 v12, s[8:11], s29 offen lds
    s_add_u32 m0, s27, 1024
    s_movk_i32 s29, 0
    buffer_load_dwordx4 v13, s[8:11], s29 offen lds
    s_add_u32 s29, s26, 0
    buffer_load_dwordx4 v[64:67], v4, s[4:7], s29 offen offset:0
    buffer_load_dwordx4 v[68:71], v4, s[4:7], s29 offen offset:1024
    buffer_load_dwordx4 v[72:75], v4, s[4:7], s29 offen offset:2048
    buffer_load_dwordx4 v[76:79], v4, s[4:7], s29 offen offset:3072
    s_add_u32 m0, s27, 8192
    s_movk_i32 s29, 128
    buffer_load_dwordx4 v12, s[8:11], s29 offen lds
    s_add_u32 m0, s27, 9216
    s_movk_i32 s29, 128
    buffer_load_dwordx4 v13, s[8:11], s29 offen lds
    s_add_u32 s29, s26, 4096
    buffer_load_dwordx4 v[80:83], v4, s[4:7], s29 offen offset:0
    buffer_load_dwordx4 v[84:87], v4, s[4:7], s29 offen offset:1024
    buffer_load_dwordx4 v[88:91], v4, s[4:7], s29 offen offset:2048
    buffer_load_dwordx4 v[92:95], v4, s[4:7], s29 offen offset:3072
    s_add_u32 m0, s27, 16384
    s_movk_i32 s29, 256
    buffer_load_dwordx4 v12, s[8:11], s29 offen lds
    s_add_u32 m0, s27, 17408
    s_movk_i32 s29, 256
    buffer_load_dwordx4 v13, s[8:11], s29 offen lds
    s_add_u32 s29, s26, 8192
    buffer_load_dwordx4 v[96:99], v4, s[4:7], s29 offen offset:0
    buffer_load_dwordx4 v[100:103], v4, s[4:7], s29 offen offset:1024
    buffer_load_dwordx4 v[104:107], v4, s[4:7], s29 offen offset:2048
    buffer_load_dwordx4 v[108:111], v4, s[4:7], s29 offen offset:3072
    s_add_u32 m0, s27, 24576
    s_movk_i32 s29, 384
    buffer_load_dwordx4 v12, s[8:11], s29 offen lds
    s_add_u32 m0, s27, 25600
    s_movk_i32 s29, 384
    buffer_load_dwordx4 v13, s[8:11], s29 offen lds
    s_add_u32 s29, s26, 12288
    buffer_load_dwordx4 v[112:115], v4, s[4:7], s29 offen offset:0
    buffer_load_dwordx4 v[116:119], v4, s[4:7], s29 offen offset:1024
    buffer_load_dwordx4 v[120:123], v4, s[4:7], s29 offen offset:2048
    buffer_load_dwordx4 v[124:127], v4, s[4:7], s29 offen offset:3072
    s_waitcnt vmcnt(18)
    s_barrier
    ds_read_b128 v[192:195], v16 offset:0
    ds_read_b128 v[196:199], v16 offset:4096
    s_add_u32 m0, s27, 32768
    s_movk_i32 s29, 512
    buffer_load_dwordx4 v12, s[8:11], s29 offen lds
    s_add_u32 m0, s27, 33792
    s_movk_i32 s29, 512
    buffer_load_dwordx4 v13, s[8:11], s29 offen lds
    s_add_u32 s29, s26, 16384
    buffer_load_dwordx4 v[128:131], v4, s[4:7], s29 offen offset:0
    buffer_load_dwordx4 v[132:135], v4, s[4:7], s29 offen offset:1024
    buffer_load_dwordx4 v[136:139], v4, s[4:7], s29 offen offset:2048
    buffer_load_dwordx4 v[140:143], v4, s[4:7], s29 offen offset:3072
    ds_read_b128 v[200:203], v17 offset:0
    ds_read_b128 v[204:207], v17 offset:4096
    s_waitcnt lgkmcnt(2)
    v_mfma_f32_32x32x16_bf16 v[32:47], v[192:195], v[64:67], v[32:47]
    v_mfma_f32_32x32x16_bf16 v[48:63], v[196:199], v[64:67], v[48:63]
    ds_read_b128 v[192:195], v18 offset:0
    ds_read_b128 v[196:199], v18 offset:4096
    s_waitcnt lgkmcnt(2)
    v_mfma_f32_32x32x16_bf16 v[32:47], v[200:203], v[68:71], v[32:47]
    v_mfma_f32_32x32x16_bf16 v[48:63], v[204:207], v[68:71], v[48:63]
    ds_read_b128 v[200:203], v19 offset:0
    ds_read_b128 v[204:207], v19 offset:4096
    s_waitcnt lgkmcnt(2)
    v_mfma_f32_32x32x16_bf16 v[32:47], v[192:195], v[72:75], v[32:47]
    v_mfma_f32_32x32x16_bf16 v[48:63], v[196:199], v[72:75], v[48:63]
    s_waitcnt lgkmcnt(0)
    v_mfma_f32_32x32x16_bf16 v[32:47], v[200:203], v[76:79], v[32:47]
    v_mfma_f32_32x32x16_bf16 v[48:63], v[204:207], v[76:79], v[48:63]
    s_waitcnt vmcnt(18)
    s_barrier
    ds_read_b128 v[192:195], v16 offset:8192
    ds_read_b128 v[196:199], v16 offset:12288
    s_add_u32 m0, s27, 40960
    s_movk_i32 s29, 640
    buffer_load_dwordx4 v12, s[8:11], s29 offen lds
    s_add_u32 m0, s27, 41984
    s_movk_i32 s29, 640
    buffer_load_dwordx4 v13, s[8:11], s29 offen lds
    s_add_u32 s29, s26, 20480
    buffer_load_dwordx4 v[144:147], v4, s[4:7], s29 offen offset:0
    buffer_load_dwordx4 v[148:151], v4, s[4:7], s29 offen offset:1024
    buffer_load_dwordx4 v[152:155], v4, s[4:7], s29 offen offset:2048
    buffer_load_dwordx4 v[156:159], v4, s[4:7], s29 offen offset:3072
    ds_read_b128 v[200:203], v17 offset:8192
    ds_read_b128 v[204:207], v17 offset:12288
    s_waitcnt lgkmcnt(2)
    v_mfma_f32_32x32x16_bf16 v[32:47], v[192:195], v[80:83], v[32:47]
    v_mfma_f32_32x32x16_bf16 v[48:63], v[196:199], v[80:83], v[48:63]
    ds_read_b128 v[192:195], v18 offset:8192
    ds_read_b128 v[196:199], v18 offset:12288
    s_waitcnt lgkmcnt(2)
    v_mfma_f32_32x32x16_bf16 v[32:47], v[200:203], v[84:87], v[32:47]
    v_mfma_f32_32x32x16_bf16 v[48:63], v[204:207], v[84:87], v[48:63]
    ds_read_b128 v[200:203], v19 offset:8192
    ds_read_b128 v[204:207], v19 offset:12288
    s_waitcnt lgkmcnt(2)
    v_mfma_f32_32x32x16_bf16 v[32:47], v[192:195], v[88:91], v[32:47]
    v_mfma_f32_32x32x16_bf16 v[48:63], v[196:199], v[88:91], v[48:63]
    s_waitcnt lgkmcnt(0)
    v_mfma_f32_32x32x16_bf16 v[32:47], v[200:203], v[92:95], v[32:47]
    v_mfma_f32_32x32x16_bf16 v[48:63], v[204:207], v[92:95], v[48:63]
    s_waitcnt vmcnt(18)
    s_barrier
    ds_read_b128 v[192:195], v16 offset:16384
    ds_read_b128 v[196:199], v16 offset:20480
    s_add_u32 m0, s27, 49152
    s_movk_i32 s29, 768
    buffer_load_dwordx4 v12, s[8:11], s29 offen lds
    s_add_u32 m0, s27, 50176
    s_movk_i32 s29, 768
    buffer_load_dwordx4 v13, s[8:11], s29 offen lds
    s_add_u32 s29, s26, 24576
    buffer_load_dwordx4 v[160:163], v4, s[4:7], s29 offen offset:0
    buffer_load_dwordx4 v[164:167], v4, s[4:7], s29 offen offset:1024
    buffer_load_dwordx4 v[168:171], v4, s[4:7], s29 offen offset:2048
    buffer_load_dwordx4 v[172:175], v4, s[4:7], s29 offen offset:3072
    ds_read_b128 v[200:203], v17 offset:16384
    ds_read_b128 v[204:207], v17 offset:20480
    s_waitcnt lgkmcnt(2)
    v_mfma_f32_32x32x16_bf16 v[32:47], v[192:195], v[96:99], v[32:47]
    v_mfma_f32_32x32x16_bf16 v[48:63], v[196:199], v[96:99], v[48:63]
    ds_read_b128 v[192:195], v18 offset:16384
    ds_read_b128 v[196:199], v18 offset:20480
    s_waitcnt lgkmcnt(2)
    v_mfma_f32_32x32x16_bf16 v[32:47], v[200:203], v[100:103], v[32:47]
    v_mfma_f32_32x32x16_bf16 v[48:63], v[204:207], v[100:103], v[48:63]
    ds_read_b128 v[200:203], v19 offset:16384
    ds_read_b128 v[204:207], v19 offset:20480
    s_waitcnt lgkmcnt(2)
    v_mfma_f32_32x32x16_bf16 v[32:47], v[192:195], v[104:107], v[32:47]
    v_mfma_f32_32x32x16_bf16 v[48:63], v[196:199], v[104:107], v[48:63]
    s_waitcnt lgkmcnt(0)
    v_mfma_f32_32x32x16_bf16 v[32:47], v[200:203], v[108:111], v[32:47]
    v_mfma_f32_32x32x16_bf16 v[48:63], v[204:207], v[108:111], v[48:63]
    s_waitcnt vmcnt(18)
    s_barrier
    ds_read_b128 v[192:195], v16 offset:24576
    ds_read_b128 v[196:199], v16 offset:28672
    s_add_u32 m0, s27, 57344
    s_movk_i32 s29, 0
    buffer_load_dwordx4 v12, s[12:15], s29 offen lds
    s_add_u32 m0, s27, 58368
    s_movk_i32 s29, 0
    buffer_load_dwordx4 v13, s[12:15], s29 offen lds
    s_add_u32 s29, s26, 28672
    buffer_load_dwordx4 v[64:67], v4, s[4:7], s29 offen offset:0
    buffer_load_dwordx4 v[68:71], v4, s[4:7], s29 offen offset:1024
    buffer_load_dwordx4 v[72:75], v4, s[4:7], s29 offen offset:2048
    buffer_load_dwordx4 v[76:79], v4, s[4:7], s29 offen offset:3072
    ds_read_b128 v[200:203], v17 offset:24576
    ds_read_b128 v[204:207], v17 offset:28672
    s_waitcnt lgkmcnt(2)
    v_mfma_f32_32x32x16_bf16 v[32:47], v[192:195], v[112:115], v[32:47]
    v_mfma_f32_32x32x16_bf16 v[48:63], v[196:199], v[112:115], v[48:63]
    ds_read_b128 v[192:195], v18 offset:24576
    ds_read_b128 v[196:199], v18 offset:28672
    s_waitcnt lgkmcnt(2)
    v_mfma_f32_32x32x16_bf16 v[32:47], v[200:203], v[116:119], v[32:47]
    v_mfma_f32_32x32x16_bf16 v[48:63], v[204:207], v[116:119], v[48:63]
    ds_read_b128 v[200:203], v19 offset:24576
    ds_read_b128 v[204:207], v19 offset:28672
    s_waitcnt lgkmcnt(2)
    v_mfma_f32_32x32x16_bf16 v[32:47], v[192:195], v[120:123], v[32:47]
    v_mfma_f32_32x32x16_bf16 v[48:63], v[196:199], v[120:123], v[48:63]
    s_waitcnt lgkmcnt(0)
    v_mfma_f32_32x32x16_bf16 v[32:47], v[200:203], v[124:127], v[32:47]
    v_mfma_f32_32x32x16_bf16 v[48:63], v[204:207], v[124:127], v[48:63]
    s_waitcnt vmcnt(18)
    s_barrier
    ds_read_b128 v[192:195], v16 offset:32768
    ds_read_b128 v[196:199], v16 offset:36864
    s_add_u32 m0, s27, 65536
    s_movk_i32 s29, 128
    buffer_load_dwordx4 v12, s[12:15], s29 offen lds
    s_add_u32 m0, s27, 66560
    s_movk_i32 s29, 128
    buffer_load_dwordx4 v13, s[12:15], s29 offen lds
    s_add_u32 s29, s26, 32768
    buffer_load_dwordx4 v[80:83], v4, s[4:7], s29 offen offset:0
    buffer_load_dwordx4 v[84:87], v4, s[4:7], s29 offen offset:1024
    buffer_load_dwordx4 v[88:91], v4, s[4:7], s29 offen offset:2048
    buffer_load_dwordx4 v[92:95], v4, s[4:7], s29 offen offset:3072
    ds_read_b128 v[200:203], v17 offset:32768
    ds_read_b128 v[204:207], v17 offset:36864
    s_waitcnt lgkmcnt(2)
    v_mfma_f32_32x32x16_bf16 v[32:47], v[192:195], v[128:131], v[32:47]
    v_mfma_f32_32x32x16_bf16 v[48:63], v[196:199], v[128:131], v[48:63]
    ds_read_b128 v[192:195], v18 offset:32768
    ds_read_b128 v[196:199], v18 offset:36864
    s_waitcnt lgkmcnt(2)
    v_mfma_f32_32x32x16_bf16 v[32:47], v[200:203], v[132:135], v[32:47]
    v_mfma_f32_32x32x16_bf16 v[48:63], v[204:207], v[132:135], v[48:63]
    ds_read_b128 v[200:203], v19 offset:32768
    ds_read_b128 v[204:207], v19 offset:36864
    s_waitcnt lgkmcnt(2)
    v_mfma_f32_32x32x16_bf16 v[32:47], v[192:195], v[136:139], v[32:47]
    v_mfma_f32_32x32x16_bf16 v[48:63], v[196:199], v[136:139], v[48:63]
    s_waitcnt lgkmcnt(0)
    v_mfma_f32_32x32x16_bf16 v[32:47], v[200:203], v[140:143], v[32:47]
    v_mfma_f32_32x32x16_bf16 v[48:63], v[204:207], v[140:143], v[48:63]
    s_waitcnt vmcnt(18)
    s_barrier
    ds_read_b128 v[192:195], v16 offset:40960
    ds_read_b128 v[196:199], v16 offset:45056
    s_add_u32 m0, s27, 73728
    s_movk_i32 s29, 256
    buffer_load_dwordx4 v12, s[12:15], s29 offen lds
    s_add_u32 m0, s27, 74752
    s_movk_i32 s29, 256
    buffer_load_dwordx4 v13, s[12:15], s29 offen lds
    s_add_u32 s29, s26, 36864
    buffer_load_dwordx4 v[96:99], v4, s[4:7], s29 offen offset:0
    buffer_load_dwordx4 v[100:103], v4, s[4:7], s29 offen offset:1024
    buffer_load_dwordx4 v[104:107], v4, s[4:7], s29 offen offset:2048
    buffer_load_dwordx4 v[108:111], v4, s[4:7], s29 offen offset:3072
    ds_read_b128 v[200:203], v17 offset:40960
    ds_read_b128 v[204:207], v17 offset:45056
    s_waitcnt lgkmcnt(2)
    v_mfma_f32_32x32x16_bf16 v[32:47], v[192:195], v[144:147], v[32:47]
    v_mfma_f32_32x32x16_bf16 v[48:63], v[196:199], v[144:147], v[48:63]
    ds_read_b128 v[192:195], v18 offset:40960
    ds_read_b128 v[196:199], v18 offset:45056
    s_waitcnt lgkmcnt(2)
    v_mfma_f32_32x32x16_bf16 v[32:47], v[200:203], v[148:151], v[32:47]
    v_mfma_f32_32x32x16_bf16 v[48:63], v[204:207], v[148:151], v[48:63]
    ds_read_b128 v[200:203], v19 offset:40960
    ds_read_b128 v[204:207], v19 offset:45056
    s_waitcnt lgkmcnt(2)
    v_mfma_f32_32x32x16_bf16 v[32:47], v[192:195], v[152:155], v[32:47]
    v_mfma_f32_32x32x16_bf16 v[48:63], v[196:199], v[152:155], v[48:63]
    s_waitcnt lgkmcnt(0)
    v_mfma_f32_32x32x16_bf16 v[32:47], v[200:203], v[156:159], v[32:47]
    v_mfma_f32_32x32x16_bf16 v[48:63], v[204:207], v[156:159], v[48:63]
    s_waitcnt vmcnt(18)
    s_barrier
    ds_read_b128 v[192:195], v16 offset:49152
    ds_read_b128 v[196:199], v16 offset:53248
    s_add_u32 m0, s27, 81920
    s_movk_i32 s29, 384
    buffer_load_dwordx4 v12, s[12:15], s29 offen lds
    s_add_u32 m0, s27, 82944
    s_movk_i32 s29, 384
    buffer_load_dwordx4 v13, s[12:15], s29 offen lds
    s_add_u32 s29, s26, 40960
    buffer_load_dwordx4 v[112:115], v4, s[4:7], s29 offen offset:0
    buffer_load_dwordx4 v[116:119], v4, s[4:7], s29 offen offset:1024
    buffer_load_dwordx4 v[120:123], v4, s[4:7], s29 offen offset:2048
    buffer_load_dwordx4 v[124:127], v4, s[4:7], s29 offen offset:3072
    ds_read_b128 v[200:203], v17 offset:49152
    ds_read_b128 v[204:207], v17 offset:53248
    s_waitcnt lgkmcnt(2)
    v_mfma_f32_32x32x16_bf16 v[32:47], v[192:195], v[160:163], v[32:47]
    v_mfma_f32_32x32x16_bf16 v[48:63], v[196:199], v[160:163], v[48:63]
    ds_read_b128 v[192:195], v18 offset:49152
    ds_read_b128 v[196:199], v18 offset:53248
    s_waitcnt lgkmcnt(2)
    v_mfma_f32_32x32x16_bf16 v[32:47], v[200:203], v[164:167], v[32:47]
    v_mfma_f32_32x32x16_bf16 v[48:63], v[204:207], v[164:167], v[48:63]
    ds_read_b128 v[200:203], v19 offset:49152
    ds_read_b128 v[204:207], v19 offset:53248
    s_waitcnt lgkmcnt(2)
    v_mfma_f32_32x32x16_bf16 v[32:47], v[192:195], v[168:171], v[32:47]
    v_mfma_f32_32x32x16_bf16 v[48:63], v[196:199], v[168:171], v[48:63]
    s_waitcnt lgkmcnt(0)
    v_mfma_f32_32x32x16_bf16 v[32:47], v[200:203], v[172:175], v[32:47]
    v_mfma_f32_32x32x16_bf16 v[48:63], v[204:207], v[172:175], v[48:63]
    s_waitcnt vmcnt(18)
    s_barrier
    ds_read_b128 v[192:195], v20 offset:0
    ds_read_b128 v[196:199], v20 offset:4096
    s_add_u32 m0, s27, 90112
    s_movk_i32 s29, 512
    buffer_load_dwordx4 v12, s[12:15], s29 offen lds
    s_add_u32 m0, s27, 91136
    s_movk_i32 s29, 512
    buffer_load_dwordx4 v13, s[12:15], s29 offen lds
    s_add_u32 s29, s26, 45056
    buffer_load_dwordx4 v[128:131], v4, s[4:7], s29 offen offset:0
    buffer_load_dwordx4 v[132:135], v4, s[4:7], s29 offen offset:1024
    buffer_load_dwordx4 v[136:139], v4, s[4:7], s29 offen offset:2048
    buffer_load_dwordx4 v[140:143], v4, s[4:7], s29 offen offset:3072
    ds_read_b128 v[200:203], v21 offset:0
    ds_read_b128 v[204:207], v21 offset:4096
    s_waitcnt lgkmcnt(2)
    v_mfma_f32_32x32x16_bf16 v[32:47], v[192:195], v[64:67], v[32:47]
    v_mfma_f32_32x32x16_bf16 v[48:63], v[196:199], v[64:67], v[48:63]
    ds_read_b128 v[192:195], v22 offset:0
    ds_read_b128 v[196:199], v22 offset:4096
    s_waitcnt lgkmcnt(2)
    v_mfma_f32_32x32x16_bf16 v[32:47], v[200:203], v[68:71], v[32:47]
    v_mfma_f32_32x32x16_bf16 v[48:63], v[204:207], v[68:71], v[48:63]
    ds_read_b128 v[200:203], v23 offset:0
    ds_read_b128 v[204:207], v23 offset:4096
    s_waitcnt lgkmcnt(2)
    v_mfma_f32_32x32x16_bf16 v[32:47], v[192:195], v[72:75], v[32:47]
    v_mfma_f32_32x32x16_bf16 v[48:63], v[196:199], v[72:75], v[48:63]
    s_waitcnt lgkmcnt(0)
    v_mfma_f32_32x32x16_bf16 v[32:47], v[200:203], v[76:79], v[32:47]
    v_mfma_f32_32x32x16_bf16 v[48:63], v[204:207], v[76:79], v[48:63]
    s_waitcnt vmcnt(18)
    s_barrier
    ds_read_b128 v[192:195], v20 offset:8192
    ds_read_b128 v[196:199], v20 offset:12288
    s_add_u32 m0, s27, 98304
    s_movk_i32 s29, 640
    buffer_load_dwordx4 v12, s[12:15], s29 offen lds
    s_add_u32 m0, s27, 99328
    s_movk_i32 s29, 640
    buffer_load_dwordx4 v13, s[12:15], s29 offen lds
    s_add_u32 s29, s26, 49152
    buffer_load_dwordx4 v[144:147], v4, s[4:7], s29 offen offset:0
    buffer_load_dwordx4 v[148:151], v4, s[4:7], s29 offen offset:1024
    buffer_load_dwordx4 v[152:155], v4, s[4:7], s29 offen offset:2048
    buffer_load_dwordx4 v[156:159], v4, s[4:7], s29 offen offset:3072
    ds_read_b128 v[200:203], v21 offset:8192
    ds_read_b128 v[204:207], v21 offset:12288
    s_waitcnt lgkmcnt(2)
    v_mfma_f32_32x32x16_bf16 v[32:47], v[192:195], v[80:83], v[32:47]
    v_mfma_f32_32x32x16_bf16 v[48:63], v[196:199], v[80:83], v[48:63]
    ds_read_b128 v[192:195], v22 offset:8192
    ds_read_b128 v[196:199], v22 offset:12288
    s_waitcnt lgkmcnt(2)
    v_mfma_f32_32x32x16_bf16 v[32:47], v[200:203], v[84:87], v[32:47]
    v_mfma_f32_32x32x16_bf16 v[48:63], v[204:207], v[84:87], v[48:63]
    ds_read_b128 v[200:203], v23 offset:8192
    ds_read_b128 v[204:207], v23 offset:12288
    s_waitcnt lgkmcnt(2)
    v_mfma_f32_32x32x16_bf16 v[32:47], v[192:195], v[88:91], v[32:47]
    v_mfma_f32_32x32x16_bf16 v[48:63], v[196:199], v[88:91], v[48:63]
    s_waitcnt lgkmcnt(0)
    v_mfma_f32_32x32x16_bf16 v[32:47], v[200:203], v[92:95], v[32:47]
    v_mfma_f32_32x32x16_bf16 v[48:63], v[204:207], v[92:95], v[48:63]
    s_waitcnt vmcnt(18)
    s_barrier
    ds_read_b128 v[192:195], v20 offset:16384
    ds_read_b128 v[196:199], v20 offset:20480
    s_add_u32 m0, s27, 106496
    s_movk_i32 s29, 768
    buffer_load_dwordx4 v12, s[12:15], s29 offen lds
    s_add_u32 m0, s27, 107520
    s_movk_i32 s29, 768
    buffer_load_dwordx4 v13, s[12:15], s29 offen lds
    s_add_u32 s29, s26, 53248
    buffer_load_dwordx4 v[160:163], v4, s[4:7], s29 offen offset:0
    buffer_load_dwordx4 v[164:167], v4, s[4:7], s29 offen offset:1024
    buffer_load_dwordx4 v[168:171], v4, s[4:7], s29 offen offset:2048
    buffer_load_dwordx4 v[172:175], v4, s[4:7], s29 offen offset:3072
    ds_read_b128 v[200:203], v21 offset:16384
    ds_read_b128 v[204:207], v21 offset:20480
    s_waitcnt lgkmcnt(2)
    v_mfma_f32_32x32x16_bf16 v[32:47], v[192:195], v[96:99], v[32:47]
    v_mfma_f32_32x32x16_bf16 v[48:63], v[196:199], v[96:99], v[48:63]
    ds_read_b128 v[192:195], v22 offset:16384
    ds_read_b128 v[196:199], v22 offset:20480
    s_waitcnt lgkmcnt(2)
    v_mfma_f32_32x32x16_bf16 v[32:47], v[200:203], v[100:103], v[32:47]
    v_mfma_f32_32x32x16_bf16 v[48:63], v[204:207], v[100:103], v[48:63]
    ds_read_b128 v[200:203], v23 offset:16384
    ds_read_b128 v[204:207], v23 offset:20480
    s_waitcnt lgkmcnt(2)
    v_mfma_f32_32x32x16_bf16 v[32:47], v[192:195], v[104:107], v[32:47]
    v_mfma_f32_32x32x16_bf16 v[48:63], v[196:199], v[104:107], v[48:63]
    s_waitcnt lgkmcnt(0)
    v_mfma_f32_32x32x16_bf16 v[32:47], v[200:203], v[108:111], v[32:47]
    v_mfma_f32_32x32x16_bf16 v[48:63], v[204:207], v[108:111], v[48:63]
    s_waitcnt vmcnt(18)
    s_barrier
    ds_read_b128 v[192:195], v20 offset:24576
    ds_read_b128 v[196:199], v20 offset:28672
    buffer_load_dwordx2 v[208:209], v24, s[52:55], 0 offen offset:0
    buffer_load_dwordx2 v[224:225], v25, s[56:59], 0 offen offset:0
    buffer_load_dwordx2 v[210:211], v24, s[52:55], 0 offen offset:16
    buffer_load_dwordx2 v[226:227], v25, s[56:59], 0 offen offset:16
    buffer_load_dwordx2 v[212:213], v24, s[52:55], 0 offen offset:32
    buffer_load_dwordx2 v[228:229], v25, s[56:59], 0 offen offset:32
    buffer_load_dwordx2 v[214:215], v24, s[52:55], 0 offen offset:48
    buffer_load_dwordx2 v[230:231], v25, s[56:59], 0 offen offset:48
    buffer_load_dwordx2 v[216:217], v24, s[52:55], 0 offen offset:64
    buffer_load_dwordx2 v[232:233], v25, s[56:59], 0 offen offset:64
    buffer_load_dwordx2 v[218:219], v24, s[52:55], 0 offen offset:80
    buffer_load_dwordx2 v[234:235], v25, s[56:59], 0 offen offset:80
    buffer_load_dwordx2 v[220:221], v24, s[52:55], 0 offen offset:96
    buffer_load_dwordx2 v[236:237], v25, s[56:59], 0 offen offset:96
    buffer_load_dwordx2 v[222:223], v24, s[52:55], 0 offen offset:112
    buffer_load_dwordx2 v[238:239], v25, s[56:59], 0 offen offset:112
    ds_read_b128 v[200:203], v21 offset:24576
    ds_read_b128 v[204:207], v21 offset:28672
    s_waitcnt lgkmcnt(2)
    v_mfma_f32_32x32x16_bf16 v[32:47], v[192:195], v[112:115], v[32:47]
    v_mfma_f32_32x32x16_bf16 v[48:63], v[196:199], v[112:115], v[48:63]
    ds_read_b128 v[192:195], v22 offset:24576
    ds_read_b128 v[196:199], v22 offset:28672
    s_waitcnt lgkmcnt(2)
    v_mfma_f32_32x32x16_bf16 v[32:47], v[200:203], v[116:119], v[32:47]
    v_mfma_f32_32x32x16_bf16 v[48:63], v[204:207], v[116:119], v[48:63]
    ds_read_b128 v[200:203], v23 offset:24576
    ds_read_b128 v[204:207], v23 offset:28672
    s_waitcnt lgkmcnt(2)
    v_mfma_f32_32x32x16_bf16 v[32:47], v[192:195], v[120:123], v[32:47]
    v_mfma_f32_32x32x16_bf16 v[48:63], v[196:199], v[120:123], v[48:63]
    s_waitcnt lgkmcnt(0)
    v_mfma_f32_32x32x16_bf16 v[32:47], v[200:203], v[124:127], v[32:47]
    v_mfma_f32_32x32x16_bf16 v[48:63], v[204:207], v[124:127], v[48:63]
    s_waitcnt vmcnt(28)
    s_barrier
    ds_read_b128 v[192:195], v20 offset:32768
    ds_read_b128 v[196:199], v20 offset:36864
    ds_read_b128 v[200:203], v21 offset:32768
    ds_read_b128 v[204:207], v21 offset:36864
    s_waitcnt lgkmcnt(2)
    v_mfma_f32_32x32x16_bf16 v[32:47], v[192:195], v[128:131], v[32:47]
    v_mfma_f32_32x32x16_bf16 v[48:63], v[196:199], v[128:131], v[48:63]
    ds_read_b128 v[192:195], v22 offset:32768
    ds_read_b128 v[196:199], v22 offset:36864
    s_waitcnt lgkmcnt(2)
    v_mfma_f32_32x32x16_bf16 v[32:47], v[200:203], v[132:135], v[32:47]
    v_mfma_f32_32x32x16_bf16 v[48:63], v[204:207], v[132:135], v[48:63]
    ds_read_b128 v[200:203], v23 offset:32768
    ds_read_b128 v[204:207], v23 offset:36864
    s_waitcnt lgkmcnt(2)
    v_mfma_f32_32x32x16_bf16 v[32:47], v[192:195], v[136:139], v[32:47]
    v_mfma_f32_32x32x16_bf16 v[48:63], v[196:199], v[136:139], v[48:63]
    s_waitcnt lgkmcnt(0)
    v_mfma_f32_32x32x16_bf16 v[32:47], v[200:203], v[140:143], v[32:47]
    v_mfma_f32_32x32x16_bf16 v[48:63], v[204:207], v[140:143], v[48:63]
    s_waitcnt vmcnt(22)
    s_barrier
    ds_read_b128 v[192:195], v20 offset:40960
    ds_read_b128 v[196:199], v20 offset:45056
    ds_read_b128 v[200:203], v21 offset:40960
    ds_read_b128 v[204:207], v21 offset:45056
    s_waitcnt lgkmcnt(2)
    v_mfma_f32_32x32x16_bf16 v[32:47], v[192:195], v[144:147], v[32:47]
    v_mfma_f32_32x32x16_bf16 v[48:63], v[196:199], v[144:147], v[48:63]
    ds_read_b128 v[192:195], v22 offset:40960
    ds_read_b128 v[196:199], v22 offset:45056
    s_waitcnt lgkmcnt(2)
    v_mfma_f32_32x32x16_bf16 v[32:47], v[200:203], v[148:151], v[32:47]
    v_mfma_f32_32x32x16_bf16 v[48:63], v[204:207], v[148:151], v[48:63]
    ds_read_b128 v[200:203], v23 offset:40960
    ds_read_b128 v[204:207], v23 offset:45056
    s_waitcnt lgkmcnt(2)
    v_mfma_f32_32x32x16_bf16 v[32:47], v[192:195], v[152:155], v[32:47]
    v_mfma_f32_32x32x16_bf16 v[48:63], v[196:199], v[152:155], v[48:63]
    s_waitcnt lgkmcnt(0)
    v_mfma_f32_32x32x16_bf16 v[32:47], v[200:203], v[156:159], v[32:47]
    v_mfma_f32_32x32x16_bf16 v[48:63], v[204:207], v[156:159], v[48:63]
    s_waitcnt vmcnt(16)
    s_barrier
    ds_read_b128 v[192:195], v20 offset:49152
    ds_read_b128 v[196:199], v20 offset:53248
    ds_read_b128 v[200:203], v21 offset:49152
    ds_read_b128 v[204:207], v21 offset:53248
    s_waitcnt lgkmcnt(2)
    v_mfma_f32_32x32x16_bf16 v[32:47], v[192:195], v[160:163], v[32:47]
    v_mfma_f32_32x32x16_bf16 v[48:63], v[196:199], v[160:163], v[48:63]
    ds_read_b128 v[192:195], v22 offset:49152
    ds_read_b128 v[196:199], v22 offset:53248
    s_waitcnt lgkmcnt(2)
    v_mfma_f32_32x32x16_bf16 v[32:47], v[200:203], v[164:167], v[32:47]
    v_mfma_f32_32x32x16_bf16 v[48:63], v[204:207], v[164:167], v[48:63]
    ds_read_b128 v[200:203], v23 offset:49152
    ds_read_b128 v[204:207], v23 offset:53248
    s_waitcnt lgkmcnt(2)
    v_mfma_f32_32x32x16_bf16 v[32:47], v[192:195], v[168:171], v[32:47]
    v_mfma_f32_32x32x16_bf16 v[48:63], v[196:199], v[168:171], v[48:63]
    s_waitcnt lgkmcnt(0)
    v_mfma_f32_32x32x16_bf16 v[32:47], v[200:203], v[172:175], v[32:47]
    v_mfma_f32_32x32x16_bf16 v[48:63], v[204:207], v[172:175], v[48:63]
    s_waitcnt vmcnt(0)
    v_lshlrev_b32 v8, 16, v208
    v_and_b32 v9, 0xffff0000, v208
    v_lshlrev_b32 v208, 16, v224
    v_and_b32 v224, 0xffff0000, v224
    v_mul_f32 v208, v208, v8
    v_mul_f32 v224, v224, v9
    v_lshlrev_b32 v8, 16, v209
    v_and_b32 v9, 0xffff0000, v209
    v_lshlrev_b32 v209, 16, v225
    v_and_b32 v225, 0xffff0000, v225
    v_mul_f32 v209, v209, v8
    v_mul_f32 v225, v225, v9
    v_fma_f32 v32, 2.0, v32, v208
    v_fma_f32 v33, 2.0, v33, v224
    v_fma_f32 v34, 2.0, v34, v209
    v_fma_f32 v35, 2.0, v35, v225
    buffer_store_dwordx4 v[32:35], v6, s[16:19], 0 offen offset:0
    v_lshlrev_b32 v8, 16, v210
    v_and_b32 v9, 0xffff0000, v210
    v_lshlrev_b32 v210, 16, v226
    v_and_b32 v226, 0xffff0000, v226
    v_mul_f32 v210, v210, v8
    v_mul_f32 v226, v226, v9
    v_lshlrev_b32 v8, 16, v211
    v_and_b32 v9, 0xffff0000, v211
    v_lshlrev_b32 v211, 16, v227
    v_and_b32 v227, 0xffff0000, v227
    v_mul_f32 v211, v211, v8
    v_mul_f32 v227, v227, v9
    v_fma_f32 v36, 2.0, v36, v210
    v_fma_f32 v37, 2.0, v37, v226
    v_fma_f32 v38, 2.0, v38, v211
    v_fma_f32 v39, 2.0, v39, v227
    buffer_store_dwordx4 v[36:39], v6, s[16:19], 0 offen offset:32
    v_lshlrev_b32 v8, 16, v212
    v_and_b32 v9, 0xffff0000, v212
    v_lshlrev_b32 v212, 16, v228
    v_and_b32 v228, 0xffff0000, v228
    v_mul_f32 v212, v212, v8
    v_mul_f32 v228, v228, v9
    v_lshlrev_b32 v8, 16, v213
    v_and_b32 v9, 0xffff0000, v213
    v_lshlrev_b32 v213, 16, v229
    v_and_b32 v229, 0xffff0000, v229
    v_mul_f32 v213, v213, v8
    v_mul_f32 v229, v229, v9
    v_fma_f32 v40, 2.0, v40, v212
    v_fma_f32 v41, 2.0, v41, v228
    v_fma_f32 v42, 2.0, v42, v213
    v_fma_f32 v43, 2.0, v43, v229
    buffer_store_dwordx4 v[40:43], v6, s[16:19], 0 offen offset:64
    v_lshlrev_b32 v8, 16, v214
    v_and_b32 v9, 0xffff0000, v214
    v_lshlrev_b32 v214, 16, v230
    v_and_b32 v230, 0xffff0000, v230
    v_mul_f32 v214, v214, v8
    v_mul_f32 v230, v230, v9
    v_lshlrev_b32 v8, 16, v215
    v_and_b32 v9, 0xffff0000, v215
    v_lshlrev_b32 v215, 16, v231
    v_and_b32 v231, 0xffff0000, v231
    v_mul_f32 v215, v215, v8
    v_mul_f32 v231, v231, v9
    v_fma_f32 v44, 2.0, v44, v214
    v_fma_f32 v45, 2.0, v45, v230
    v_fma_f32 v46, 2.0, v46, v215
    v_fma_f32 v47, 2.0, v47, v231
    buffer_store_dwordx4 v[44:47], v6, s[16:19], 0 offen offset:96
    v_lshlrev_b32 v8, 16, v216
    v_and_b32 v9, 0xffff0000, v216
    v_lshlrev_b32 v216, 16, v232
    v_and_b32 v232, 0xffff0000, v232
    v_mul_f32 v216, v216, v8
    v_mul_f32 v232, v232, v9
    v_lshlrev_b32 v8, 16, v217
    v_and_b32 v9, 0xffff0000, v217
    v_lshlrev_b32 v217, 16, v233
    v_and_b32 v233, 0xffff0000, v233
    v_mul_f32 v217, v217, v8
    v_mul_f32 v233, v233, v9
    v_fma_f32 v48, 2.0, v48, v216
    v_fma_f32 v49, 2.0, v49, v232
    v_fma_f32 v50, 2.0, v50, v217
    v_fma_f32 v51, 2.0, v51, v233
    buffer_store_dwordx4 v[48:51], v6, s[16:19], 0 offen offset:128
    v_lshlrev_b32 v8, 16, v218
    v_and_b32 v9, 0xffff0000, v218
    v_lshlrev_b32 v218, 16, v234
    v_and_b32 v234, 0xffff0000, v234
    v_mul_f32 v218, v218, v8
    v_mul_f32 v234, v234, v9
    v_lshlrev_b32 v8, 16, v219
    v_and_b32 v9, 0xffff0000, v219
    v_lshlrev_b32 v219, 16, v235
    v_and_b32 v235, 0xffff0000, v235
    v_mul_f32 v219, v219, v8
    v_mul_f32 v235, v235, v9
    v_fma_f32 v52, 2.0, v52, v218
    v_fma_f32 v53, 2.0, v53, v234
    v_fma_f32 v54, 2.0, v54, v219
    v_fma_f32 v55, 2.0, v55, v235
    buffer_store_dwordx4 v[52:55], v6, s[16:19], 0 offen offset:160
    v_lshlrev_b32 v8, 16, v220
    v_and_b32 v9, 0xffff0000, v220
    v_lshlrev_b32 v220, 16, v236
    v_and_b32 v236, 0xffff0000, v236
    v_mul_f32 v220, v220, v8
    v_mul_f32 v236, v236, v9
    v_lshlrev_b32 v8, 16, v221
    v_and_b32 v9, 0xffff0000, v221
    v_lshlrev_b32 v221, 16, v237
    v_and_b32 v237, 0xffff0000, v237
    v_mul_f32 v221, v221, v8
    v_mul_f32 v237, v237, v9
    v_fma_f32 v56, 2.0, v56, v220
    v_fma_f32 v57, 2.0, v57, v236
    v_fma_f32 v58, 2.0, v58, v221
    v_fma_f32 v59, 2.0, v59, v237
    buffer_store_dwordx4 v[56:59], v6, s[16:19], 0 offen offset:192
    v_lshlrev_b32 v8, 16, v222
    v_and_b32 v9, 0xffff0000, v222
    v_lshlrev_b32 v222, 16, v238
    v_and_b32 v238, 0xffff0000, v238
    v_mul_f32 v222, v222, v8
    v_mul_f32 v238, v238, v9
    v_lshlrev_b32 v8, 16, v223
    v_and_b32 v9, 0xffff0000, v223
    v_lshlrev_b32 v223, 16, v239
    v_and_b32 v239, 0xffff0000, v239
    v_mul_f32 v223, v223, v8
    v_mul_f32 v239, v239, v9
    v_fma_f32 v60, 2.0, v60, v222
    v_fma_f32 v61, 2.0, v61, v238
    v_fma_f32 v62, 2.0, v62, v223
    v_fma_f32 v63, 2.0, v63, v239
    buffer_store_dwordx4 v[60:63], v6, s[16:19], 0 offen offset:224
    s_endpgm
K3_B:
    s_load_dwordx2 s[44:45], s[0:1], 88
    s_mul_i32 s24, s3, 120
    v_lshrrev_b32 v8, 3, v2
    v_add_u32 v8, s24, v8
    v_mul_u32_u24 v8, 896, v8
    v_bfe_u32 v9, v2, 4, 1
    v_lshlrev_b32 v9, 2, v9
    v_and_b32 v10, 7, v2
    v_xor_b32 v9, v9, v10
    v_lshl_add_u32 v12, v9, 4, v8
    s_lshl_b32 s24, s21, 7
    v_add_u32 v12, s24, v12
    v_lshlrev_b32 v8, 2, v3
    v_bfe_u32 v9, v2, 2, 2
    v_add_u32 v8, v8, v9
    v_lshlrev_b32 v8, 7, v8
    v_bfe_u32 v9, v2, 4, 1
    v_lshl_add_u32 v8, v9, 5, v8
    v_and_b32 v9, 3, v2
    v_lshl_add_u32 v8, v9, 3, v8
    v_bfe_u32 v9, v2, 3, 1
    v_lshl_add_u32 v16, v9, 6, v8
    v_xor_b32 v17, 64, v16
    v_add_u32 v6, 1792, v6
    s_waitcnt lgkmcnt(0)
    s_mov_b32 s4, s40
    s_and_b32 s5, s41, 0xffff
    s_mov_b32 s6, 19660800
    s_mov_b32 s7, 0x00020000
    s_mov_b32 s8, s44
    s_and_b32 s9, s45, 0xffff
    s_mov_b32 s10, 401408
    s_mov_b32 s11, 0x00020000
    s_mov_b32 s16, s42
    s_and_b32 s17, s43, 0xffff
    s_mov_b32 s18, 7340032
    s_mov_b32 s19, 0x00020000
    s_mul_i32 s27, s3, 15360
    s_add_u32 m0, s27, 0
    s_movk_i32 s29, 0
    buffer_load_dwordx4 v12, s[8:11], 0 offen lds
    v_add_u32 v12, 7168, v12
    s_add_u32 m0, s27, 1024
    s_movk_i32 s29, 0
    buffer_load_dwordx4 v12, s[8:11], 0 offen lds
    v_add_u32 v12, 7168, v12
    s_add_u32 m0, s27, 2048
    s_movk_i32 s29, 0
    buffer_load_dwordx4 v12, s[8:11], 0 offen lds
    v_add_u32 v12, 7168, v12
    s_add_u32 m0, s27, 3072
    s_movk_i32 s29, 0
    buffer_load_dwordx4 v12, s[8:11], 0 offen lds
    v_add_u32 v12, 7168, v12
    s_add_u32 m0, s27, 4096
    s_movk_i32 s29, 0
    buffer_load_dwordx4 v12, s[8:11], 0 offen lds
    v_add_u32 v12, 7168, v12
    s_add_u32 m0, s27, 5120
    s_movk_i32 s29, 0
    buffer_load_dwordx4 v12, s[8:11], 0 offen lds
    v_add_u32 v12, 7168, v12
    s_add_u32 m0, s27, 6144
    s_movk_i32 s29, 0
    buffer_load_dwordx4 v12, s[8:11], 0 offen lds
    v_add_u32 v12, 7168, v12
    s_add_u32 m0, s27, 7168
    s_movk_i32 s29, 0
    buffer_load_dwordx4 v12, s[8:11], 0 offen lds
    v_add_u32 v12, 7168, v12
    s_add_u32 m0, s27, 8192
    s_movk_i32 s29, 0
    buffer_load_dwordx4 v12, s[8:11], 0 offen lds
    v_add_u32 v12, 7168, v12
    s_add_u32 m0, s27, 9216
    s_movk_i32 s29, 0
    buffer_load_dwordx4 v12, s[8:11], 0 offen lds
    v_add_u32 v12, 7168, v12
    s_add_u32 m0, s27, 10240
    s_movk_i32 s29, 0
    buffer_load_dwordx4 v12, s[8:11], 0 offen lds
    v_add_u32 v12, 7168, v12
    s_add_u32 m0, s27, 11264
    s_movk_i32 s29, 0
    buffer_load_dwordx4 v12, s[8:11], 0 offen lds
    v_add_u32 v12, 7168, v12
    s_add_u32 m0, s27, 12288
    s_movk_i32 s29, 0
    buffer_load_dwordx4 v12, s[8:11], 0 offen lds
    v_add_u32 v12, 7168, v12
    s_add_u32 m0, s27, 13312
    s_movk_i32 s29, 0
    buffer_load_dwordx4 v12, s[8:11], 0 offen lds
    v_add_u32 v12, 7168, v12
    s_add_u32 m0, s27, 14336
    s_movk_i32 s29, 0
    buffer_load_dwordx4 v12, s[8:11], 0 offen lds
    s_lshl_b32 s26, s22, 15
    s_add_u32 s26, s26, 17563648
    s_add_u32 s29, s26, 0
    buffer_load_dwordx4 v[64:67], v4, s[4:7], s29 offen offset:0
    buffer_load_dwordx4 v[68:71], v4, s[4:7], s29 offen offset:1024
    buffer_load_dwordx4 v[72:75], v4, s[4:7], s29 offen offset:2048
    buffer_load_dwordx4 v[76:79], v4, s[4:7], s29 offen offset:3072
    s_add_u32 s29, s26, 4096
    buffer_load_dwordx4 v[80:83], v4, s[4:7], s29 offen offset:0
    buffer_load_dwordx4 v[84:87], v4, s[4:7], s29 offen offset:1024
    buffer_load_dwordx4 v[88:91], v4, s[4:7], s29 offen offset:2048
    buffer_load_dwordx4 v[92:95], v4, s[4:7], s29 offen offset:3072
    s_add_u32 s29, s26, 8192
    buffer_load_dwordx4 v[96:99], v4, s[4:7], s29 offen offset:0
    buffer_load_dwordx4 v[100:103], v4, s[4:7], s29 offen offset:1024
    buffer_load_dwordx4 v[104:107], v4, s[4:7], s29 offen offset:2048
    buffer_load_dwordx4 v[108:111], v4, s[4:7], s29 offen offset:3072
    s_waitcnt vmcnt(12)
    s_barrier
    ds_read_b64_tr_b16 v[192:193], v16 offset:0
    ds_read_b64_tr_b16 v[194:195], v16 offset:1024
    ds_read_b64_tr_b16 v[196:197], v17 offset:0
    ds_read_b64_tr_b16 v[198:199], v17 offset:1024
    s_add_u32 s29, s26, 12288
    buffer_load_dwordx4 v[112:115], v4, s[4:7], s29 offen offset:0
    ds_read_b64_tr_b16 v[200:201], v16 offset:2048
    ds_read_b64_tr_b16 v[202:203], v16 offset:3072
    ds_read_b64_tr_b16 v[204:205], v17 offset:2048
    ds_read_b64_tr_b16 v[206:207], v17 offset:3072
    s_waitcnt vmcnt(12) lgkmcnt(4)
    v_mfma_f32_32x32x16_bf16 v[32:47], v[192:195], v[64:67], v[32:47]
    v_mfma_f32_32x32x16_bf16 v[48:63], v[196:199], v[64:67], v[48:63]
    buffer_load_dwordx4 v[116:119], v4, s[4:7], s29 offen offset:1024
    ds_read_b64_tr_b16 v[192:193], v16 offset:3584
    ds_read_b64_tr_b16 v[194:195], v16 offset:4608
    ds_read_b64_tr_b16 v[196:197], v17 offset:3584
    ds_read_b64_tr_b16 v[198:199], v17 offset:4608
    s_waitcnt vmcnt(12) lgkmcnt(4)
    v_mfma_f32_32x32x16_bf16 v[32:47], v[200:203], v[68:71], v[32:47]
    v_mfma_f32_32x32x16_bf16 v[48:63], v[204:207], v[68:71], v[48:63]
    buffer_load_dwordx4 v[120:123], v4, s[4:7], s29 offen offset:2048
    ds_read_b64_tr_b16 v[200:201], v16 offset:5632
    ds_read_b64_tr_b16 v[202:203], v16 offset:6656
    ds_read_b64_tr_b16 v[204:205], v17 offset:5632
    ds_read_b64_tr_b16 v[206:207], v17 offset:6656
    s_waitcnt vmcnt(12) lgkmcnt(4)
    v_mfma_f32_32x32x16_bf16 v[32:47], v[192:195], v[72:75], v[32:47]
    v_mfma_f32_32x32x16_bf16 v[48:63], v[196:199], v[72:75], v[48:63]
    buffer_load_dwordx4 v[124:127], v4, s[4:7], s29 offen offset:3072
    ds_read_b64_tr_b16 v[192:193], v16 offset:7168
    ds_read_b64_tr_b16 v[194:195], v16 offset:8192
    ds_read_b64_tr_b16 v[196:197], v17 offset:7168
    ds_read_b64_tr_b16 v[198:199], v17 offset:8192
    s_waitcnt vmcnt(12) lgkmcnt(4)
    v_mfma_f32_32x32x16_bf16 v[32:47], v[200:203], v[76:79], v[32:47]
    v_mfma_f32_32x32x16_bf16 v[48:63], v[204:207], v[76:79], v[48:63]
    s_add_u32 s29, s26, 16384
    buffer_load_dwordx4 v[128:131], v4, s[4:7], s29 offen offset:0
    ds_read_b64_tr_b16 v[200:201], v16 offset:9216
    ds_read_b64_tr_b16 v[202:203], v16 offset:10240
    ds_read_b64_tr_b16 v[204:205], v17 offset:9216
    ds_read_b64_tr_b16 v[206:207], v17 offset:10240
    s_waitcnt vmcnt(12) lgkmcnt(4)
    v_mfma_f32_32x32x16_bf16 v[32:47], v[192:195], v[80:83], v[32:47]
    v_mfma_f32_32x32x16_bf16 v[48:63], v[196:199], v[80:83], v[48:63]
    buffer_load_dwordx4 v[132:135], v4, s[4:7], s29 offen offset:1024
    ds_read_b64_tr_b16 v[192:193], v16 offset:10752
    ds_read_b64_tr_b16 v[194:195], v16 offset:11776
    ds_read_b64_tr_b16 v[196:197], v17 offset:10752
    ds_read_b64_tr_b16 v[198:199], v17 offset:11776
    s_waitcnt vmcnt(12) lgkmcnt(4)
    v_mfma_f32_32x32x16_bf16 v[32:47], v[200:203], v[84:87], v[32:47]
    v_mfma_f32_32x32x16_bf16 v[48:63], v[204:207], v[84:87], v[48:63]
    buffer_load_dwordx4 v[136:139], v4, s[4:7], s29 offen offset:2048
    ds_read_b64_tr_b16 v[200:201], v16 offset:12800
    ds_read_b64_tr_b16 v[202:203], v16 offset:13824
    ds_read_b64_tr_b16 v[204:205], v17 offset:12800
    ds_read_b64_tr_b16 v[206:207], v17 offset:13824
    s_waitcnt vmcnt(12) lgkmcnt(4)
    v_mfma_f32_32x32x16_bf16 v[32:47], v[192:195], v[88:91], v[32:47]
    v_mfma_f32_32x32x16_bf16 v[48:63], v[196:199], v[88:91], v[48:63]
    buffer_load_dwordx4 v[140:143], v4, s[4:7], s29 offen offset:3072
    ds_read_b64_tr_b16 v[192:193], v16 offset:14336
    ds_read_b64_tr_b16 v[194:195], v16 offset:15360
    ds_read_b64_tr_b16 v[196:197], v17 offset:14336
    ds_read_b64_tr_b16 v[198:199], v17 offset:15360
    s_waitcnt vmcnt(12) lgkmcnt(4)
    v_mfma_f32_32x32x16_bf16 v[32:47], v[200:203], v[92:95], v[32:47]
    v_mfma_f32_32x32x16_bf16 v[48:63], v[204:207], v[92:95], v[48:63]
    s_add_u32 s29, s26, 20480
    buffer_load_dwordx4 v[144:147], v4, s[4:7], s29 offen offset:0
    ds_read_b64_tr_b16 v[200:201], v16 offset:16384
    ds_read_b64_tr_b16 v[202:203], v16 offset:17408
    ds_read_b64_tr_b16 v[204:205], v17 offset:16384
    ds_read_b64_tr_b16 v[206:207], v17 offset:17408
    s_waitcnt vmcnt(12) lgkmcnt(4)
    v_mfma_f32_32x32x16_bf16 v[32:47], v[192:195], v[96:99], v[32:47]
    v_mfma_f32_32x32x16_bf16 v[48:63], v[196:199], v[96:99], v[48:63]
    buffer_load_dwordx4 v[148:151], v4, s[4:7], s29 offen offset:1024
    ds_read_b64_tr_b16 v[192:193], v16 offset:17920
    ds_read_b64_tr_b16 v[194:195], v16 offset:18944
    ds_read_b64_tr_b16 v[196:197], v17 offset:17920
    ds_read_b64_tr_b16 v[198:199], v17 offset:18944
    s_waitcnt vmcnt(12) lgkmcnt(4)
    v_mfma_f32_32x32x16_bf16 v[32:47], v[200:203], v[100:103], v[32:47]
    v_mfma_f32_32x32x16_bf16 v[48:63], v[204:207], v[100:103], v[48:63]
    buffer_load_dwordx4 v[152:155], v4, s[4:7], s29 offen offset:2048
    ds_read_b64_tr_b16 v[200:201], v16 offset:19968
    ds_read_b64_tr_b16 v[202:203], v16 offset:20992
    ds_read_b64_tr_b16 v[204:205], v17 offset:19968
    ds_read_b64_tr_b16 v[206:207], v17 offset:20992
    s_waitcnt vmcnt(12) lgkmcnt(4)
    v_mfma_f32_32x32x16_bf16 v[32:47], v[192:195], v[104:107], v[32:47]
    v_mfma_f32_32x32x16_bf16 v[48:63], v[196:199], v[104:107], v[48:63]
    buffer_load_dwordx4 v[156:159], v4, s[4:7], s29 offen offset:3072
    ds_read_b64_tr_b16 v[192:193], v16 offset:21504
    ds_read_b64_tr_b16 v[194:195], v16 offset:22528
    ds_read_b64_tr_b16 v[196:197], v17 offset:21504
    ds_read_b64_tr_b16 v[198:199], v17 offset:22528
    s_waitcnt vmcnt(12) lgkmcnt(4)
    v_mfma_f32_32x32x16_bf16 v[32:47], v[200:203], v[108:111], v[32:47]
    v_mfma_f32_32x32x16_bf16 v[48:63], v[204:207], v[108:111], v[48:63]
    s_add_u32 s29, s26, 24576
    buffer_load_dwordx4 v[160:163], v4, s[4:7], s29 offen offset:0
    ds_read_b64_tr_b16 v[200:201], v16 offset:23552
    ds_read_b64_tr_b16 v[202:203], v16 offset:24576
    ds_read_b64_tr_b16 v[204:205], v17 offset:23552
    ds_read_b64_tr_b16 v[206:207], v17 offset:24576
    s_waitcnt vmcnt(12) lgkmcnt(4)
    v_mfma_f32_32x32x16_bf16 v[32:47], v[192:195], v[112:115], v[32:47]
    v_mfma_f32_32x32x16_bf16 v[48:63], v[196:199], v[112:115], v[48:63]
    buffer_load_dwordx4 v[164:167], v4, s[4:7], s29 offen offset:1024
    ds_read_b64_tr_b16 v[192:193], v16 offset:25088
    ds_read_b64_tr_b16 v[194:195], v16 offset:26112
    ds_read_b64_tr_b16 v[196:197], v17 offset:25088
    ds_read_b64_tr_b16 v[198:199], v17 offset:26112
    s_waitcnt vmcnt(12) lgkmcnt(4)
    v_mfma_f32_32x32x16_bf16 v[32:47], v[200:203], v[116:119], v[32:47]
    v_mfma_f32_32x32x16_bf16 v[48:63], v[204:207], v[116:119], v[48:63]
    buffer_load_dwordx4 v[168:171], v4, s[4:7], s29 offen offset:2048
    ds_read_b64_tr_b16 v[200:201], v16 offset:27136
    ds_read_b64_tr_b16 v[202:203], v16 offset:28160
    ds_read_b64_tr_b16 v[204:205], v17 offset:27136
    ds_read_b64_tr_b16 v[206:207], v17 offset:28160
    s_waitcnt vmcnt(12) lgkmcnt(4)
    v_mfma_f32_32x32x16_bf16 v[32:47], v[192:195], v[120:123], v[32:47]
    v_mfma_f32_32x32x16_bf16 v[48:63], v[196:199], v[120:123], v[48:63]
    buffer_load_dwordx4 v[172:175], v4, s[4:7], s29 offen offset:3072
    ds_read_b64_tr_b16 v[192:193], v16 offset:28672
    ds_read_b64_tr_b16 v[194:195], v16 offset:29696
    ds_read_b64_tr_b16 v[196:197], v17 offset:28672
    ds_read_b64_tr_b16 v[198:199], v17 offset:29696
    s_waitcnt vmcnt(12) lgkmcnt(4)
    v_mfma_f32_32x32x16_bf16 v[32:47], v[200:203], v[124:127], v[32:47]
    v_mfma_f32_32x32x16_bf16 v[48:63], v[204:207], v[124:127], v[48:63]
    s_add_u32 s29, s26, 28672
    buffer_load_dwordx4 v[176:179], v4, s[4:7], s29 offen offset:0
    ds_read_b64_tr_b16 v[200:201], v16 offset:30720
    ds_read_b64_tr_b16 v[202:203], v16 offset:31744
    ds_read_b64_tr_b16 v[204:205], v17 offset:30720
    ds_read_b64_tr_b16 v[206:207], v17 offset:31744
    s_waitcnt vmcnt(12) lgkmcnt(4)
    v_mfma_f32_32x32x16_bf16 v[32:47], v[192:195], v[128:131], v[32:47]
    v_mfma_f32_32x32x16_bf16 v[48:63], v[196:199], v[128:131], v[48:63]
    buffer_load_dwordx4 v[180:183], v4, s[4:7], s29 offen offset:1024
    ds_read_b64_tr_b16 v[192:193], v16 offset:32256
    ds_read_b64_tr_b16 v[194:195], v16 offset:33280
    ds_read_b64_tr_b16 v[196:197], v17 offset:32256
    ds_read_b64_tr_b16 v[198:199], v17 offset:33280
    s_waitcnt vmcnt(12) lgkmcnt(4)
    v_mfma_f32_32x32x16_bf16 v[32:47], v[200:203], v[132:135], v[32:47]
    v_mfma_f32_32x32x16_bf16 v[48:63], v[204:207], v[132:135], v[48:63]
    buffer_load_dwordx4 v[184:187], v4, s[4:7], s29 offen offset:2048
    ds_read_b64_tr_b16 v[200:201], v16 offset:34304
    ds_read_b64_tr_b16 v[202:203], v16 offset:35328
    ds_read_b64_tr_b16 v[204:205], v17 offset:34304
    ds_read_b64_tr_b16 v[206:207], v17 offset:35328
    s_waitcnt vmcnt(12) lgkmcnt(4)
    v_mfma_f32_32x32x16_bf16 v[32:47], v[192:195], v[136:139], v[32:47]
    v_mfma_f32_32x32x16_bf16 v[48:63], v[196:199], v[136:139], v[48:63]
    buffer_load_dwordx4 v[188:191], v4, s[4:7], s29 offen offset:3072
    ds_read_b64_tr_b16 v[192:193], v16 offset:35840
    ds_read_b64_tr_b16 v[194:195], v16 offset:36864
    ds_read_b64_tr_b16 v[196:197], v17 offset:35840
    ds_read_b64_tr_b16 v[198:199], v17 offset:36864
    s_waitcnt vmcnt(12) lgkmcnt(4)
    v_mfma_f32_32x32x16_bf16 v[32:47], v[200:203], v[140:143], v[32:47]
    v_mfma_f32_32x32x16_bf16 v[48:63], v[204:207], v[140:143], v[48:63]
    ds_read_b64_tr_b16 v[200:201], v16 offset:37888
    ds_read_b64_tr_b16 v[202:203], v16 offset:38912
    ds_read_b64_tr_b16 v[204:205], v17 offset:37888
    ds_read_b64_tr_b16 v[206:207], v17 offset:38912
    s_waitcnt vmcnt(11) lgkmcnt(4)
    v_mfma_f32_32x32x16_bf16 v[32:47], v[192:195], v[144:147], v[32:47]
    v_mfma_f32_32x32x16_bf16 v[48:63], v[196:199], v[144:147], v[48:63]
    ds_read_b64_tr_b16 v[192:193], v16 offset:39424
    ds_read_b64_tr_b16 v[194:195], v16 offset:40448
    ds_read_b64_tr_b16 v[196:197], v17 offset:39424
    ds_read_b64_tr_b16 v[198:199], v17 offset:40448
    s_waitcnt vmcnt(10) lgkmcnt(4)
    v_mfma_f32_32x32x16_bf16 v[32:47], v[200:203], v[148:151], v[32:47]
    v_mfma_f32_32x32x16_bf16 v[48:63], v[204:207], v[148:151], v[48:63]
    ds_read_b64_tr_b16 v[200:201], v16 offset:41472
    ds_read_b64_tr_b16 v[202:203], v16 offset:42496
    ds_read_b64_tr_b16 v[204:205], v17 offset:41472
    ds_read_b64_tr_b16 v[206:207], v17 offset:42496
    s_waitcnt vmcnt(9) lgkmcnt(4)
    v_mfma_f32_32x32x16_bf16 v[32:47], v[192:195], v[152:155], v[32:47]
    v_mfma_f32_32x32x16_bf16 v[48:63], v[196:199], v[152:155], v[48:63]
    ds_read_b64_tr_b16 v[192:193], v16 offset:43008
    ds_read_b64_tr_b16 v[194:195], v16 offset:44032
    ds_read_b64_tr_b16 v[196:197], v17 offset:43008
    ds_read_b64_tr_b16 v[198:199], v17 offset:44032
    s_waitcnt vmcnt(8) lgkmcnt(4)
    v_mfma_f32_32x32x16_bf16 v[32:47], v[200:203], v[156:159], v[32:47]
    v_mfma_f32_32x32x16_bf16 v[48:63], v[204:207], v[156:159], v[48:63]
    ds_read_b64_tr_b16 v[200:201], v16 offset:45056
    ds_read_b64_tr_b16 v[202:203], v16 offset:46080
    ds_read_b64_tr_b16 v[204:205], v17 offset:45056
    ds_read_b64_tr_b16 v[206:207], v17 offset:46080
    s_waitcnt vmcnt(7) lgkmcnt(4)
    v_mfma_f32_32x32x16_bf16 v[32:47], v[192:195], v[160:163], v[32:47]
    v_mfma_f32_32x32x16_bf16 v[48:63], v[196:199], v[160:163], v[48:63]
    ds_read_b64_tr_b16 v[192:193], v16 offset:46592
    ds_read_b64_tr_b16 v[194:195], v16 offset:47616
    ds_read_b64_tr_b16 v[196:197], v17 offset:46592
    ds_read_b64_tr_b16 v[198:199], v17 offset:47616
    s_waitcnt vmcnt(6) lgkmcnt(4)
    v_mfma_f32_32x32x16_bf16 v[32:47], v[200:203], v[164:167], v[32:47]
    v_mfma_f32_32x32x16_bf16 v[48:63], v[204:207], v[164:167], v[48:63]
    ds_read_b64_tr_b16 v[200:201], v16 offset:48640
    ds_read_b64_tr_b16 v[202:203], v16 offset:49664
    ds_read_b64_tr_b16 v[204:205], v17 offset:48640
    ds_read_b64_tr_b16 v[206:207], v17 offset:49664
    s_waitcnt vmcnt(5) lgkmcnt(4)
    v_mfma_f32_32x32x16_bf16 v[32:47], v[192:195], v[168:171], v[32:47]
    v_mfma_f32_32x32x16_bf16 v[48:63], v[196:199], v[168:171], v[48:63]
    ds_read_b64_tr_b16 v[192:193], v16 offset:50176
    ds_read_b64_tr_b16 v[194:195], v16 offset:51200
    ds_read_b64_tr_b16 v[196:197], v17 offset:50176
    ds_read_b64_tr_b16 v[198:199], v17 offset:51200
    s_waitcnt vmcnt(4) lgkmcnt(4)
    v_mfma_f32_32x32x16_bf16 v[32:47], v[200:203], v[172:175], v[32:47]
    v_mfma_f32_32x32x16_bf16 v[48:63], v[204:207], v[172:175], v[48:63]
    ds_read_b64_tr_b16 v[200:201], v16 offset:52224
    ds_read_b64_tr_b16 v[202:203], v16 offset:53248
    ds_read_b64_tr_b16 v[204:205], v17 offset:52224
    ds_read_b64_tr_b16 v[206:207], v17 offset:53248
    s_waitcnt vmcnt(3) lgkmcnt(4)
    v_mfma_f32_32x32x16_bf16 v[32:47], v[192:195], v[176:179], v[32:47]
    v_mfma_f32_32x32x16_bf16 v[48:63], v[196:199], v[176:179], v[48:63]
    ds_read_b64_tr_b16 v[192:193], v16 offset:53760
    ds_read_b64_tr_b16 v[194:195], v16 offset:54784
    ds_read_b64_tr_b16 v[196:197], v17 offset:53760
    ds_read_b64_tr_b16 v[198:199], v17 offset:54784
    s_waitcnt vmcnt(2) lgkmcnt(4)
    v_mfma_f32_32x32x16_bf16 v[32:47], v[200:203], v[180:183], v[32:47]
    v_mfma_f32_32x32x16_bf16 v[48:63], v[204:207], v[180:183], v[48:63]
    ds_read_b64_tr_b16 v[200:201], v16 offset:55808
    ds_read_b64_tr_b16 v[202:203], v16 offset:56832
    ds_read_b64_tr_b16 v[204:205], v17 offset:55808
    ds_read_b64_tr_b16 v[206:207], v17 offset:56832
    s_waitcnt vmcnt(1) lgkmcnt(4)
    v_mfma_f32_32x32x16_bf16 v[32:47], v[192:195], v[184:187], v[32:47]
    v_mfma_f32_32x32x16_bf16 v[48:63], v[196:199], v[184:187], v[48:63]
    s_waitcnt vmcnt(0) lgkmcnt(0)
    v_mfma_f32_32x32x16_bf16 v[32:47], v[200:203], v[188:191], v[32:47]
    v_mfma_f32_32x32x16_bf16 v[48:63], v[204:207], v[188:191], v[48:63]
    s_nop 7
    s_nop 3
    buffer_store_dwordx4 v[32:35], v6, s[16:19], 0 offen offset:0
    buffer_store_dwordx4 v[36:39], v6, s[16:19], 0 offen offset:32
    buffer_store_dwordx4 v[40:43], v6, s[16:19], 0 offen offset:64
    buffer_store_dwordx4 v[44:47], v6, s[16:19], 0 offen offset:96
    buffer_store_dwordx4 v[48:51], v6, s[16:19], 0 offen offset:128
    buffer_store_dwordx4 v[52:55], v6, s[16:19], 0 offen offset:160
    buffer_store_dwordx4 v[56:59], v6, s[16:19], 0 offen offset:192
    buffer_store_dwordx4 v[60:63], v6, s[16:19], 0 offen offset:224
K3_END:
    s_endpgm
.section .rodata,"a"
.p2align 6
.amdhsa_kernel k1_proj_kernel
  .amdhsa_next_free_vgpr 172
  .amdhsa_next_free_sgpr 102
  .amdhsa_accum_offset 172
  .amdhsa_group_segment_fixed_size 0
  .amdhsa_kernarg_size 120
  .amdhsa_user_sgpr_count 2
  .amdhsa_user_sgpr_kernarg_segment_ptr 1
  .amdhsa_system_sgpr_workgroup_id_x 1
.end_amdhsa_kernel
.p2align 6
.amdhsa_kernel k2_attn_kernel
  .amdhsa_next_free_vgpr 128
  .amdhsa_next_free_sgpr 102
  .amdhsa_accum_offset 128
  .amdhsa_group_segment_fixed_size 0
  .amdhsa_kernarg_size 120
  .amdhsa_user_sgpr_count 2
  .amdhsa_user_sgpr_kernarg_segment_ptr 1
  .amdhsa_system_sgpr_workgroup_id_x 1
.end_amdhsa_kernel
.p2align 6
.amdhsa_kernel k3_out_kernel
  .amdhsa_next_free_vgpr 240
  .amdhsa_next_free_sgpr 102
  .amdhsa_accum_offset 240
  .amdhsa_group_segment_fixed_size 0
  .amdhsa_kernarg_size 120
  .amdhsa_user_sgpr_count 2
  .amdhsa_user_sgpr_kernarg_segment_ptr 1
  .amdhsa_system_sgpr_workgroup_id_x 1
.end_amdhsa_kernel
```
